```python
import torch

def _softmax(x, axis=-1):
    return torch.softmax(x, dim=axis)
def _gelu(x):
    return torch.nn.functional.gelu(x, approximate="tanh")
def _silu(x):
    return torch.nn.functional.silu(x)
def _sigmoid(x):
    return torch.sigmoid(x)
def _layernorm(x, axis=-1, eps=1e-5):
    m = x.mean(dim=axis, keepdim=True)
    v = x.var(dim=axis, keepdim=True, unbiased=False)
    return (x - m) / torch.sqrt(v + eps)
def _scatter_add(tgt, idx, src, axis=0):
    return tgt.clone().index_add_(axis, idx, src)
def _segment_sum(src, seg, n):
    out = torch.zeros((n,) + src.shape[1:], dtype=src.dtype)
    return out.index_add_(0, seg, src)
def _pad(x, pw):
    flat = tuple(v for pair in reversed(pw) for v in pair)
    return torch.nn.functional.pad(x, flat)

kernel_name = 'concat_heads__gqa_block_cached__gqa_block_cached__near_ridge'

def setup_inputs():

    _w = (lambda a: (lambda t: t.to(torch.bfloat16) if t.is_floating_point() else t)(torch.as_tensor(a)))
    def _A_setup():
        B, Sq, D = 8, 96, 640
        Hq, Hkv, Sk, Dh = 32, 32, 96, 128
        assert Hq % Hkv == 0, (Hq, Hkv)
        return {
            "x": _w((lambda *s: torch.randn(*s, dtype=torch.bfloat16) * 0.8)(B, Sq, D)),
            "k_cache": _w((lambda *s: torch.randn(*s, dtype=torch.bfloat16) * 0.8)(B, Hkv, Sk, Dh)),
            "v_cache": _w((lambda *s: torch.randn(*s, dtype=torch.bfloat16) * 0.05)(B, Hkv, Sk, Dh)),
            "wq": _w((lambda *s: torch.randn(*s, dtype=torch.bfloat16) * 0.8)(D, Hq * Dh) * (D ** -0.5)),
            "wo": _w((lambda *s: torch.randn(*s, dtype=torch.bfloat16) * 0.05)(Hq * Dh, D) * ((Hq * Dh) ** -0.5)),
        }
    _A_in = _A_setup()

    def _B_setup():
        B, Sq, D = 8, 96, 640
        Hq, Hkv, Sk, Dh = 32, 32, 96, 128
        assert Hq % Hkv == 0, (Hq, Hkv)
        return {
            "x": _w((lambda *s: torch.randn(*s, dtype=torch.bfloat16) * 0.8)(B, Sq, D)),
            "k_cache": _w((lambda *s: torch.randn(*s, dtype=torch.bfloat16) * 0.8)(B, Hkv, Sk, Dh)),
            "v_cache": _w((lambda *s: torch.randn(*s, dtype=torch.bfloat16) * 0.05)(B, Hkv, Sk, Dh)),
            "wq": _w((lambda *s: torch.randn(*s, dtype=torch.bfloat16) * 0.8)(D, Hq * Dh) * (D ** -0.5)),
            "wo": _w((lambda *s: torch.randn(*s, dtype=torch.bfloat16) * 0.05)(Hq * Dh, D) * ((Hq * Dh) ** -0.5)),
        }
    _B_in = _B_setup()

    return {
        "A_x": _A_in["x"],
        "A_k_cache": _A_in["k_cache"],
        "A_v_cache": _A_in["v_cache"],
        "A_wq": _A_in["wq"],
        "A_wo": _A_in["wo"],
        "B_x": _B_in["x"],
        "B_k_cache": _B_in["k_cache"],
        "B_v_cache": _B_in["v_cache"],
        "B_wq": _B_in["wq"],
        "B_wo": _B_in["wo"],
    }

def reference(A_x, A_k_cache, A_v_cache, A_wq, A_wo, B_x, B_k_cache, B_v_cache, B_wq, B_wo):
    def _A_ref(x, k_cache, v_cache, wq, wo):
        B, Sq, D = x.shape
        Hq, Dh = 32, 128
        Hkv = k_cache.shape[1]
        rep = Hq // Hkv
        q = (lambda x, *d: x.permute(*d))((x @ wq).reshape(B, Sq, Hq, Dh), 0, 2, 1, 3)
        k = (lambda x, n, axis: torch.repeat_interleave(x, n, dim=axis))(k_cache, rep, axis=1)
        v = (lambda x, n, axis: torch.repeat_interleave(x, n, dim=axis))(v_cache, rep, axis=1)
        scores = torch.einsum("bhqd,bhkd->bhqk", q, k) * (Dh ** -0.5)
        p = _softmax(scores, axis=-1)
        o = torch.einsum("bhqk,bhkd->bhqd", p, v)
        return (lambda x, *d: x.permute(*d))(o, 0, 2, 1, 3).reshape(B, Sq, Hq * Dh) @ wo

    def _B_ref(x, k_cache, v_cache, wq, wo):
        B, Sq, D = x.shape
        Hq, Dh = 32, 128
        Hkv = k_cache.shape[1]
        rep = Hq // Hkv
        q = (lambda x, *d: x.permute(*d))((x @ wq).reshape(B, Sq, Hq, Dh), 0, 2, 1, 3)
        k = (lambda x, n, axis: torch.repeat_interleave(x, n, dim=axis))(k_cache, rep, axis=1)
        v = (lambda x, n, axis: torch.repeat_interleave(x, n, dim=axis))(v_cache, rep, axis=1)
        scores = torch.einsum("bhqd,bhkd->bhqk", q, k) * (Dh ** -0.5)
        p = _softmax(scores, axis=-1)
        o = torch.einsum("bhqk,bhkd->bhqd", p, v)
        return (lambda x, *d: x.permute(*d))(o, 0, 2, 1, 3).reshape(B, Sq, Hq * Dh) @ wo

    a = _A_ref(A_x, A_k_cache, A_v_cache, A_wq, A_wo)
    b = _B_ref(B_x, B_k_cache, B_v_cache, B_wq, B_wo)
    return torch.concatenate([a, b], axis=-1)
```

```asm
; @launch grid=(256,1,1) block=(256,1,1) lds=163840
.amdgcn_target "amdgcn-amd-amdhsa--gfx950"
.text
.p2align 8
CODE_BEGIN:
.globl concat_heads__gqa_block_cached__gqa_block_cached__near_ridge_kernel
.p2align 8
.type concat_heads__gqa_block_cached__gqa_block_cached__near_ridge_kernel,@function
concat_heads__gqa_block_cached__gqa_block_cached__near_ridge_kernel:

    s_cmp_ge_u32 s2, 256
    s_cbranch_scc1 K_end

    s_load_dwordx8 s[32:39], s[0:1], 0
    s_load_dwordx4 s[40:43], s[0:1], 32
    s_load_dwordx8 s[44:51], s[0:1], 48
    s_load_dwordx4 s[52:55], s[0:1], 80
    s_load_dwordx2 s[24:25], s[0:1], 96
    s_memrealtime s[72:73]

    s_getpc_b64 s[98:99]
C_touch_ref:
    s_sub_u32 s98, s98, C_touch_ref-CODE_BEGIN
    s_subb_u32 s99, s99, 0
    s_lshl_b32 s3, s2, 7
    s_and_b32 s3, s3, 0x7c00
    s_min_u32 s3, s3, CODE_END-CODE_BEGIN-1024
    v_lshl_add_u32 v20, v0, 2, s3
    global_load_dword v21, v20, s[98:99]

    v_lshrrev_b32 v1, 6, v0
    v_and_b32 v0, 63, v0
    s_bfe_u32 s5, s2, 0x10002
    v_readfirstlane_b32 s4, v1
    s_and_b32 s6, s2, 3
    s_lshl_b32 s6, s6, 3
    s_bfe_u32 s56, s2, 0x30003
    s_add_u32 s6, s6, s56
    s_lshr_b32 s7, s2, 6
    v_lshrrev_b32 v236, 3, v0
    v_and_b32 v237, 7, v0
    v_lshrrev_b32 v238, 4, v0
    v_xor_b32 v237, v237, v238
    v_mul_u32_u24 v241, 1280, v236
    v_lshl_add_u32 v236, v237, 4, v241
    s_lshl_b32 s3, s7, 2
    s_add_u32 s3, s3, s4
    s_mul_i32 s3, s3, 61440
    v_add_u32 v236, s3, v236
    v_xor_b32 v237, 64, v236

    v_add_u32 v212, 0, v236
    v_add_u32 v213, 9216, v237
    v_add_u32 v214, 18432, v236
    v_add_u32 v215, 27648, v237

    v_and_b32 v239, 15, v0
    v_lshlrev_b32 v236, 1, v238
    v_xor_b32 v240, v239, v236
    s_and_b32 s3, s4, 1
    s_lshl_b32 s3, s3, 3
    v_xor_b32 v237, s3, v240
    v_lshlrev_b32 v236, 13, v238
    v_lshl_add_u32 v236, v237, 4, v236
    s_lshl_b32 s3, s4, 16
    s_lshl_b32 s58, s6, 8
    s_add_u32 s3, s3, s58
    v_add_u32 v216, s3, v236
    v_add_u32 v217, 31744, v216

    s_mul_i32 s69, s7, 1
    s_add_u32 s69, s69, s56
    s_mul_i32 s3, s69, 52
    s_lshr_b32 s3, s3, 8
    s_mul_i32 s3, s3, 5
    s_sub_u32 s69, s69, s3
    s_mul_i32 s60, s7, 1
    s_add_u32 s60, s60, s56
    s_mul_i32 s3, s60, 52
    s_lshr_b32 s3, s3, 8
    s_mul_i32 s3, s3, 5
    s_sub_u32 s60, s60, s3

    s_mul_i32 s59, s4, 6144
    s_lshl_b32 s57, s4, 11
    s_cmp_eq_u32 s5, 1
    s_waitcnt lgkmcnt(0)

    s_cselect_b64 s[8:9], s[42:43], s[32:33]
    s_mov_b32 s10, 983040
    s_mov_b32 s11, 0x00020000
    s_cselect_b64 s[12:13], s[48:49], s[38:39]
    s_mov_b32 s14, 5242880
    s_mov_b32 s15, 0x00020000
    s_add_u32 m0, s57, 24576
    s_add_u32 s58, s69, 0
    s_lshl_b32 s70, s58, 19
    s_lshl_b32 s71, s58, 7
    buffer_load_dwordx4 v216, s[12:15], s70 offen offset:0  lds
    buffer_load_dwordx4 v217, s[12:15], s70 offen offset:1024  lds
    s_add_u32 m0, s59, 0
    s_nop 0
    buffer_load_dwordx4 v212, s[8:11], s71 offen offset:0  lds
    buffer_load_dwordx4 v213, s[8:11], s71 offen offset:1024  lds
    buffer_load_dwordx4 v214, s[8:11], s71 offen offset:2048  lds
    buffer_load_dwordx4 v215, s[8:11], s71 offen offset:3072  lds
    s_add_u32 m0, s59, 4096
    s_add_u32 s71, s71, 40960
    buffer_load_dwordx4 v212, s[8:11], s71 offen offset:0  lds
    buffer_load_dwordx4 v213, s[8:11], s71 offen offset:1024  lds
    s_add_u32 m0, s57, 32768
    s_add_u32 s70, s70, 262144
    buffer_load_dwordx4 v216, s[12:15], s70 offen offset:0  lds
    buffer_load_dwordx4 v217, s[12:15], s70 offen offset:1024  lds
    s_cmp_eq_u32 s5, 1
    s_cselect_b64 s[16:17], s[44:45], s[34:35]
    s_mov_b32 s18, 6291456
    s_mov_b32 s19, 0x00020000
    s_cselect_b64 s[20:21], s[46:47], s[36:37]
    s_mov_b32 s22, 6291456
    s_mov_b32 s23, 0x00020000
    s_cselect_b64 s[28:29], s[50:51], s[40:41]
    s_mov_b32 s30, 5242880
    s_mov_b32 s31, 0x00020000

    s_mov_b32 s26, 0x10000000
    s_mov_b32 s27, 0x00020000
    s_mov_b32 s32, s54
    s_mov_b32 s33, s55
    s_mov_b32 s34, 256
    s_mov_b32 s35, 0x00020000
    s_mov_b32 s36, s52
    s_mov_b32 s37, s53
    s_mov_b32 s38, 1966080
    s_mov_b32 s39, 0x00020000
    v_mov_b32 v24, 0
    s_or_b32 s3, s2, s4
    s_cmp_lg_u32 s3, 0
    s_cbranch_scc1 C_notok
    s_or_b32 s72, s72, 1
    v_mov_b32 v22, s72
    v_mov_b32 v23, s73
    s_mov_b64 exec, 1
    buffer_store_dwordx2 v[22:23], v24, s[32:35], 0 offen sc0 sc1
    s_mov_b64 exec, -1
C_notok:

    s_lshl_b32 s74, s7, 6
    s_add_u32 s74, s74, s6
    s_mul_i32 s74, s74, 24576
    s_lshr_b32 s43, s4, 1
    s_mul_i32 s43, s43, 774144
    s_add_u32 s74, s74, s59
    s_add_u32 s43, s43, s74
    v_lshlrev_b32 v236, 8, v238
    v_lshl_add_u32 v222, v240, 4, v236
    v_xor_b32 v223, 128, v222
    v_xor_b32 v237, v239, v238
    v_lshl_add_u32 v237, v237, 4, v236
    s_and_b32 s3, s4, 1
    s_lshl_b32 s3, s3, 7
    v_xor_b32 v218, s3, v237
    v_xor_b32 v219, 64, v218
    v_xor_b32 v220, 128, v218
    v_xor_b32 v221, 192, v218
    s_mov_b32 s46, s60
    s_mov_b32 s47, s61
    s_bfe_u32 s60, s2, 0x10001
    s_and_b32 s61, s2, 1
    s_lshr_b32 s3, s2, 3
    s_mul_i32 s63, s3, 43
    s_lshr_b32 s63, s63, 8
    s_mul_i32 s62, s63, 6
    s_sub_u32 s62, s3, s62
    s_mul_i32 s61, s61, 5
    s_add_u32 s61, s61, s63
    s_lshl_b32 s61, s61, 7
    s_lshl_b32 s64, s62, 4
    s_mul_i32 s3, s4, 0
    s_lshr_b32 s3, s3, 1
    s_add_u32 s64, s64, s3
    s_mul_i32 s64, s64, 43
    s_lshr_b32 s64, s64, 8

    s_add_u32 s48, s62, s4
    s_lshl_b32 s3, s60, 2
    s_add_u32 s65, s3, s4
    s_mul_i32 s66, s65, 655360
    s_lshl_b32 s67, s4, 12

    v_lshrrev_b32 v236, 3, v0
    v_mul_u32_u24 v236, 1280, v236
    v_and_b32 v237, 7, v0
    v_lshrrev_b32 v238, 4, v0
    v_lshlrev_b32 v238, 1, v238
    v_xor_b32 v237, v237, v238
    v_lshl_add_u32 v236, v237, 4, v236
    v_add_u32 v224, s61, v236

    v_add_u32 v225, 9216, v224
    v_add_u32 v226, 18432, v224
    v_add_u32 v227, 27648, v224

    v_lshrrev_b32 v236, 2, v0
    v_lshlrev_b32 v236, 7, v236
    v_bfe_u32 v237, v0, 3, 2
    v_lshl_add_u32 v236, v237, 5, v236
    v_and_b32 v237, 3, v0
    v_lshl_add_u32 v236, v237, 3, v236
    s_add_u32 s3, s67, 0
    v_add_u32 v228, s3, v236

    v_xor_b32 v229, 32, v228
    v_xor_b32 v230, 64, v228
    v_xor_b32 v231, 96, v228

    v_and_b32 v16, 15, v0
    v_lshrrev_b32 v17, 4, v0
    v_lshrrev_b32 v18, 1, v16
    v_xor_b32 v18, v17, v18
    v_lshlrev_b32 v18, 4, v18
    v_lshl_add_u32 v18, v16, 7, v18
    v_add_u32 v2, s59, v18
    v_xor_b32 v3, 64, v2
    v_add_u32 v4, 114688, v2
    v_add_u32 v5, 114688, v3
    v_lshrrev_b32 v18, 5, v0
    v_xor_b32 v18, v18, v16
    v_lshlrev_b32 v18, 4, v18
    v_lshl_add_u32 v18, v16, 8, v18
    v_bfe_u32 v19, v0, 4, 1
    v_lshl_add_u32 v18, v19, 3, v18
    s_lshr_b32 s42, s4, 1
    s_mul_i32 s42, s42, 24576
    s_lshr_b32 s3, s42, 1
    s_add_u32 s3, s3, 90112
    v_add_u32 v14, s3, v18
    v_bfe_u32 v16, v0, 2, 3
    v_and_b32 v18, 3, v0
    v_lshlrev_b32 v18, 3, v18
    v_lshl_add_u32 v1, v16, 5, v18
    v_lshrrev_b32 v16, 2, v0
    v_lshlrev_b32 v16, 8, v16
    s_add_u32 s3, s42, 114688
    v_add3_u32 v15, v16, s3, v1
    v_bfe_u32 v16, v0, 2, 2
    v_lshl_add_u32 v16, v17, 3, v16
    v_lshl_add_u32 v6, v16, 8, v1
    v_add_u32 v6, 24576, v6

    v_xor_b32 v7, 32, v6
    v_xor_b32 v8, 64, v6
    v_xor_b32 v9, 96, v6
    v_xor_b32 v10, 128, v6
    v_xor_b32 v11, 160, v6
    v_xor_b32 v12, 192, v6
    v_xor_b32 v13, 224, v6
    v_xor_b32 v244, 0, v14
    v_xor_b32 v245, 32, v14
    v_xor_b32 v246, 64, v14
    v_xor_b32 v247, 96, v14
    v_xor_b32 v248, 128, v14
    v_xor_b32 v249, 160, v14
    v_xor_b32 v250, 192, v14
    v_xor_b32 v251, 224, v14
    s_add_u32 m0, s57, 40960
    s_add_u32 s58, s69, 1
    s_cmp_ge_u32 s58, 5
    s_cselect_b32 s3, 5, 0
    s_sub_u32 s58, s58, s3
    s_lshl_b32 s70, s58, 19
    s_lshl_b32 s75, s58, 7
    buffer_load_dwordx4 v216, s[12:15], s70 offen offset:0  lds
    buffer_load_dwordx4 v217, s[12:15], s70 offen offset:1024  lds
    s_add_u32 m0, s59, 114688
    s_nop 0
    buffer_load_dwordx4 v212, s[8:11], s75 offen offset:0  lds
    buffer_load_dwordx4 v213, s[8:11], s75 offen offset:1024  lds
    buffer_load_dwordx4 v214, s[8:11], s75 offen offset:2048  lds
    buffer_load_dwordx4 v215, s[8:11], s75 offen offset:3072  lds
    s_add_u32 m0, s59, 118784
    s_add_u32 s75, s75, 40960
    buffer_load_dwordx4 v212, s[8:11], s75 offen offset:0  lds
    buffer_load_dwordx4 v213, s[8:11], s75 offen offset:1024  lds
    s_waitcnt vmcnt(8)
    s_barrier
    ds_read_b128 v[156:159], v2 offset:0
    ds_read_b128 v[160:163], v2 offset:2048
    ds_read_b128 v[164:167], v2 offset:4096
    ds_read_b64_tr_b16 v[124:125], v6 offset:0
    ds_read_b64_tr_b16 v[126:127], v6 offset:1024
    ds_read_b64_tr_b16 v[128:129], v7 offset:0
    ds_read_b64_tr_b16 v[130:131], v7 offset:1024
    ds_read_b64_tr_b16 v[132:133], v8 offset:0
    ds_read_b64_tr_b16 v[134:135], v8 offset:1024
    ds_read_b64_tr_b16 v[136:137], v9 offset:0
    ds_read_b64_tr_b16 v[138:139], v9 offset:1024
    ds_read_b64_tr_b16 v[140:141], v10 offset:0
    ds_read_b64_tr_b16 v[142:143], v10 offset:1024
    ds_read_b64_tr_b16 v[144:145], v11 offset:0
    ds_read_b64_tr_b16 v[146:147], v11 offset:1024
    ds_read_b64_tr_b16 v[148:149], v12 offset:0
    ds_read_b64_tr_b16 v[150:151], v12 offset:1024
    ds_read_b64_tr_b16 v[152:153], v13 offset:0
    ds_read_b64_tr_b16 v[154:155], v13 offset:1024
    s_waitcnt lgkmcnt(0)
    v_mfma_f32_16x16x32_bf16 v[28:31], v[124:127], v[156:159], 0
    ds_read_b128 v[200:203], v3 offset:0
    ds_read_b128 v[204:207], v3 offset:2048
    s_add_u32 m0, s57, 49152
    s_add_u32 s70, s70, 262144
    buffer_load_dwordx4 v216, s[12:15], s70 offen offset:0  lds
    v_mfma_f32_16x16x32_bf16 v[60:63], v[124:127], v[160:163], 0
    ds_read_b128 v[208:211], v3 offset:4096
    buffer_load_dwordx4 v217, s[12:15], s70 offen offset:1024  lds
    v_mfma_f32_16x16x32_bf16 v[92:95], v[124:127], v[164:167], 0
    ds_read_b64_tr_b16 v[168:169], v6 offset:8192
    ds_read_b64_tr_b16 v[170:171], v6 offset:9216
    s_add_u32 m0, s57, 57344
    s_add_u32 s58, s69, 2
    s_cmp_ge_u32 s58, 5
    s_cselect_b32 s3, 5, 0
    s_sub_u32 s58, s58, s3
    s_lshl_b32 s70, s58, 19
    s_lshl_b32 s100, s58, 7
    buffer_load_dwordx4 v216, s[12:15], s70 offen offset:0  lds
    v_mfma_f32_16x16x32_bf16 v[32:35], v[128:131], v[156:159], 0
    ds_read_b64_tr_b16 v[172:173], v7 offset:8192
    buffer_load_dwordx4 v217, s[12:15], s70 offen offset:1024  lds
    v_mfma_f32_16x16x32_bf16 v[64:67], v[128:131], v[160:163], 0
    ds_read_b64_tr_b16 v[174:175], v7 offset:9216
    ds_read_b64_tr_b16 v[176:177], v8 offset:8192
    v_mfma_f32_16x16x32_bf16 v[96:99], v[128:131], v[164:167], 0
    ds_read_b64_tr_b16 v[178:179], v8 offset:9216
    s_add_u32 m0, s59, 139264
    s_nop 0
    buffer_load_dwordx4 v212, s[8:11], s100 offen offset:0  lds
    v_mfma_f32_16x16x32_bf16 v[36:39], v[132:135], v[156:159], 0
    ds_read_b64_tr_b16 v[180:181], v9 offset:8192
    ds_read_b64_tr_b16 v[182:183], v9 offset:9216
    buffer_load_dwordx4 v213, s[8:11], s100 offen offset:1024  lds
    v_mfma_f32_16x16x32_bf16 v[68:71], v[132:135], v[160:163], 0
    ds_read_b64_tr_b16 v[184:185], v10 offset:8192
    buffer_load_dwordx4 v214, s[8:11], s100 offen offset:2048  lds
    v_mfma_f32_16x16x32_bf16 v[100:103], v[132:135], v[164:167], 0
    ds_read_b64_tr_b16 v[186:187], v10 offset:9216
    ds_read_b64_tr_b16 v[188:189], v11 offset:8192
    v_mfma_f32_16x16x32_bf16 v[40:43], v[136:139], v[156:159], 0
    ds_read_b64_tr_b16 v[190:191], v11 offset:9216
    buffer_load_dwordx4 v215, s[8:11], s100 offen offset:3072  lds
    v_mfma_f32_16x16x32_bf16 v[72:75], v[136:139], v[160:163], 0
    ds_read_b64_tr_b16 v[192:193], v12 offset:8192
    ds_read_b64_tr_b16 v[194:195], v12 offset:9216
    s_add_u32 m0, s59, 143360
    s_add_u32 s100, s100, 40960
    buffer_load_dwordx4 v212, s[8:11], s100 offen offset:0  lds
    v_mfma_f32_16x16x32_bf16 v[104:107], v[136:139], v[164:167], 0
    ds_read_b64_tr_b16 v[196:197], v13 offset:8192
    buffer_load_dwordx4 v213, s[8:11], s100 offen offset:1024  lds
    v_mfma_f32_16x16x32_bf16 v[44:47], v[140:143], v[156:159], 0
    ds_read_b64_tr_b16 v[198:199], v13 offset:9216
    v_mfma_f32_16x16x32_bf16 v[76:79], v[140:143], v[160:163], 0
    s_add_u32 m0, s57, 65536
    s_add_u32 s70, s70, 262144
    buffer_load_dwordx4 v216, s[12:15], s70 offen offset:0  lds
    v_mfma_f32_16x16x32_bf16 v[108:111], v[140:143], v[164:167], 0
    buffer_load_dwordx4 v217, s[12:15], s70 offen offset:1024  lds
    v_mfma_f32_16x16x32_bf16 v[48:51], v[144:147], v[156:159], 0
    s_add_u32 m0, s57, 73728
    s_add_u32 s58, s69, 3
    s_cmp_ge_u32 s58, 5
    s_cselect_b32 s3, 5, 0
    s_sub_u32 s58, s58, s3
    s_lshl_b32 s70, s58, 19
    s_lshl_b32 s101, s58, 7
    buffer_load_dwordx4 v216, s[12:15], s70 offen offset:0  lds
    v_mfma_f32_16x16x32_bf16 v[80:83], v[144:147], v[160:163], 0
    v_mfma_f32_16x16x32_bf16 v[112:115], v[144:147], v[164:167], 0
    buffer_load_dwordx4 v217, s[12:15], s70 offen offset:1024  lds
    v_mfma_f32_16x16x32_bf16 v[52:55], v[148:151], v[156:159], 0
    s_add_u32 m0, s57, 81920
    s_add_u32 s70, s70, 262144
    buffer_load_dwordx4 v216, s[12:15], s70 offen offset:0  lds
    v_mfma_f32_16x16x32_bf16 v[84:87], v[148:151], v[160:163], 0
    buffer_load_dwordx4 v217, s[12:15], s70 offen offset:1024  lds
    v_mfma_f32_16x16x32_bf16 v[116:119], v[148:151], v[164:167], 0
    v_mfma_f32_16x16x32_bf16 v[56:59], v[152:155], v[156:159], 0
    s_waitcnt lgkmcnt(0)
    v_mfma_f32_16x16x32_bf16 v[88:91], v[152:155], v[160:163], 0
    s_waitcnt vmcnt(14)
    s_barrier
    v_mfma_f32_16x16x32_bf16 v[120:123], v[152:155], v[164:167], 0
    v_mfma_f32_16x16x32_bf16 v[28:31], v[168:171], v[200:203], v[28:31]
    ds_read_b128 v[156:159], v4 offset:0
    ds_read_b128 v[160:163], v4 offset:2048
    s_add_u32 m0, s59, 0
    s_nop 0
    buffer_load_dwordx4 v212, s[8:11], s101 offen offset:0  lds
    v_mfma_f32_16x16x32_bf16 v[60:63], v[168:171], v[204:207], v[60:63]
    ds_read_b128 v[164:167], v4 offset:4096
    v_mfma_f32_16x16x32_bf16 v[92:95], v[168:171], v[208:211], v[92:95]
    ds_read_b64_tr_b16 v[124:125], v6 offset:16384
    ds_read_b64_tr_b16 v[126:127], v6 offset:17408
    buffer_load_dwordx4 v213, s[8:11], s101 offen offset:1024  lds
    v_mfma_f32_16x16x32_bf16 v[32:35], v[172:175], v[200:203], v[32:35]
    ds_read_b64_tr_b16 v[128:129], v7 offset:16384
    v_mfma_f32_16x16x32_bf16 v[64:67], v[172:175], v[204:207], v[64:67]
    ds_read_b64_tr_b16 v[130:131], v7 offset:17408
    ds_read_b64_tr_b16 v[132:133], v8 offset:16384
    v_mfma_f32_16x16x32_bf16 v[96:99], v[172:175], v[208:211], v[96:99]
    ds_read_b64_tr_b16 v[134:135], v8 offset:17408
    buffer_load_dwordx4 v214, s[8:11], s101 offen offset:2048  lds
    v_mfma_f32_16x16x32_bf16 v[36:39], v[176:179], v[200:203], v[36:39]
    ds_read_b64_tr_b16 v[136:137], v9 offset:16384
    ds_read_b64_tr_b16 v[138:139], v9 offset:17408
    v_mfma_f32_16x16x32_bf16 v[68:71], v[176:179], v[204:207], v[68:71]
    ds_read_b64_tr_b16 v[140:141], v10 offset:16384
    v_mfma_f32_16x16x32_bf16 v[100:103], v[176:179], v[208:211], v[100:103]
    ds_read_b64_tr_b16 v[142:143], v10 offset:17408
    ds_read_b64_tr_b16 v[144:145], v11 offset:16384
    buffer_load_dwordx4 v215, s[8:11], s101 offen offset:3072  lds
    v_mfma_f32_16x16x32_bf16 v[40:43], v[180:183], v[200:203], v[40:43]
    ds_read_b64_tr_b16 v[146:147], v11 offset:17408
    v_mfma_f32_16x16x32_bf16 v[72:75], v[180:183], v[204:207], v[72:75]
    ds_read_b64_tr_b16 v[148:149], v12 offset:16384
    ds_read_b64_tr_b16 v[150:151], v12 offset:17408
    v_mfma_f32_16x16x32_bf16 v[104:107], v[180:183], v[208:211], v[104:107]
    ds_read_b64_tr_b16 v[152:153], v13 offset:16384
    s_add_u32 m0, s59, 4096
    s_add_u32 s101, s101, 40960
    buffer_load_dwordx4 v212, s[8:11], s101 offen offset:0  lds
    v_mfma_f32_16x16x32_bf16 v[44:47], v[184:187], v[200:203], v[44:47]
    ds_read_b64_tr_b16 v[154:155], v13 offset:17408
    v_mfma_f32_16x16x32_bf16 v[76:79], v[184:187], v[204:207], v[76:79]
    v_mfma_f32_16x16x32_bf16 v[108:111], v[184:187], v[208:211], v[108:111]
    buffer_load_dwordx4 v213, s[8:11], s101 offen offset:1024  lds
    v_mfma_f32_16x16x32_bf16 v[48:51], v[188:191], v[200:203], v[48:51]
    v_mfma_f32_16x16x32_bf16 v[80:83], v[188:191], v[204:207], v[80:83]
    v_mfma_f32_16x16x32_bf16 v[112:115], v[188:191], v[208:211], v[112:115]
    s_add_u32 m0, s57, 24576
    s_add_u32 s58, s69, 4
    s_cmp_ge_u32 s58, 5
    s_cselect_b32 s3, 5, 0
    s_sub_u32 s58, s58, s3
    s_lshl_b32 s70, s58, 19
    s_lshl_b32 s71, s58, 7
    buffer_load_dwordx4 v216, s[12:15], s70 offen offset:0  lds
    v_mfma_f32_16x16x32_bf16 v[52:55], v[192:195], v[200:203], v[52:55]
    v_mfma_f32_16x16x32_bf16 v[84:87], v[192:195], v[204:207], v[84:87]
    v_mfma_f32_16x16x32_bf16 v[116:119], v[192:195], v[208:211], v[116:119]
    buffer_load_dwordx4 v217, s[12:15], s70 offen offset:1024  lds
    v_mfma_f32_16x16x32_bf16 v[56:59], v[196:199], v[200:203], v[56:59]
    v_mfma_f32_16x16x32_bf16 v[88:91], v[196:199], v[204:207], v[88:91]
    v_mfma_f32_16x16x32_bf16 v[120:123], v[196:199], v[208:211], v[120:123]
    s_waitcnt lgkmcnt(0)
    v_mfma_f32_16x16x32_bf16 v[28:31], v[124:127], v[156:159], v[28:31]
    ds_read_b128 v[200:203], v5 offset:0
    ds_read_b128 v[204:207], v5 offset:2048
    s_add_u32 m0, s57, 32768
    s_add_u32 s70, s70, 262144
    buffer_load_dwordx4 v216, s[12:15], s70 offen offset:0  lds
    v_mfma_f32_16x16x32_bf16 v[60:63], v[124:127], v[160:163], v[60:63]
    ds_read_b128 v[208:211], v5 offset:4096
    v_mfma_f32_16x16x32_bf16 v[92:95], v[124:127], v[164:167], v[92:95]
    ds_read_b64_tr_b16 v[168:169], v6 offset:24576
    ds_read_b64_tr_b16 v[170:171], v6 offset:25600
    buffer_load_dwordx4 v217, s[12:15], s70 offen offset:1024  lds
    v_mfma_f32_16x16x32_bf16 v[32:35], v[128:131], v[156:159], v[32:35]
    ds_read_b64_tr_b16 v[172:173], v7 offset:24576
    v_mfma_f32_16x16x32_bf16 v[64:67], v[128:131], v[160:163], v[64:67]
    ds_read_b64_tr_b16 v[174:175], v7 offset:25600
    ds_read_b64_tr_b16 v[176:177], v8 offset:24576
    v_mfma_f32_16x16x32_bf16 v[96:99], v[128:131], v[164:167], v[96:99]
    ds_read_b64_tr_b16 v[178:179], v8 offset:25600
    s_add_u32 m0, s59, 90112
    s_add_u32 s68, s43, 0
    buffer_load_dwordx4 v218, s[16:19], s68 offen offset:0 nt lds
    v_mfma_f32_16x16x32_bf16 v[36:39], v[132:135], v[156:159], v[36:39]
    ds_read_b64_tr_b16 v[180:181], v9 offset:24576
    ds_read_b64_tr_b16 v[182:183], v9 offset:25600
    v_mfma_f32_16x16x32_bf16 v[68:71], v[132:135], v[160:163], v[68:71]
    ds_read_b64_tr_b16 v[184:185], v10 offset:24576
    buffer_load_dwordx4 v219, s[16:19], s68 offen offset:1024 nt lds
    v_mfma_f32_16x16x32_bf16 v[100:103], v[132:135], v[164:167], v[100:103]
    ds_read_b64_tr_b16 v[186:187], v10 offset:25600
    ds_read_b64_tr_b16 v[188:189], v11 offset:24576
    v_mfma_f32_16x16x32_bf16 v[40:43], v[136:139], v[156:159], v[40:43]
    ds_read_b64_tr_b16 v[190:191], v11 offset:25600
    v_mfma_f32_16x16x32_bf16 v[72:75], v[136:139], v[160:163], v[72:75]
    ds_read_b64_tr_b16 v[192:193], v12 offset:24576
    ds_read_b64_tr_b16 v[194:195], v12 offset:25600
    buffer_load_dwordx4 v220, s[16:19], s68 offen offset:2048 nt lds
    v_mfma_f32_16x16x32_bf16 v[104:107], v[136:139], v[164:167], v[104:107]
    ds_read_b64_tr_b16 v[196:197], v13 offset:24576
    v_mfma_f32_16x16x32_bf16 v[44:47], v[140:143], v[156:159], v[44:47]
    ds_read_b64_tr_b16 v[198:199], v13 offset:25600
    v_mfma_f32_16x16x32_bf16 v[76:79], v[140:143], v[160:163], v[76:79]
    buffer_load_dwordx4 v221, s[16:19], s68 offen offset:3072 nt lds
    v_mfma_f32_16x16x32_bf16 v[108:111], v[140:143], v[164:167], v[108:111]
    v_mfma_f32_16x16x32_bf16 v[48:51], v[144:147], v[156:159], v[48:51]
    s_add_u32 m0, s59, 94208
    s_add_u32 s68, s43, 4096
    buffer_load_dwordx4 v218, s[16:19], s68 offen offset:0 nt lds
    v_mfma_f32_16x16x32_bf16 v[80:83], v[144:147], v[160:163], v[80:83]
    v_mfma_f32_16x16x32_bf16 v[112:115], v[144:147], v[164:167], v[112:115]
    v_mfma_f32_16x16x32_bf16 v[52:55], v[148:151], v[156:159], v[52:55]
    buffer_load_dwordx4 v219, s[16:19], s68 offen offset:1024 nt lds
    v_mfma_f32_16x16x32_bf16 v[84:87], v[148:151], v[160:163], v[84:87]
    v_mfma_f32_16x16x32_bf16 v[116:119], v[148:151], v[164:167], v[116:119]
    v_mfma_f32_16x16x32_bf16 v[56:59], v[152:155], v[156:159], v[56:59]
    s_waitcnt lgkmcnt(0)
    v_mfma_f32_16x16x32_bf16 v[88:91], v[152:155], v[160:163], v[88:91]
    s_waitcnt vmcnt(20)
    s_barrier
    v_mfma_f32_16x16x32_bf16 v[120:123], v[152:155], v[164:167], v[120:123]
    v_mfma_f32_16x16x32_bf16 v[28:31], v[168:171], v[200:203], v[28:31]
    ds_read_b128 v[156:159], v4 offset:24576
    ds_read_b128 v[160:163], v4 offset:26624
    s_add_u32 m0, s59, 114688
    s_nop 0
    buffer_load_dwordx4 v212, s[8:11], s71 offen offset:0  lds
    v_mfma_f32_16x16x32_bf16 v[60:63], v[168:171], v[204:207], v[60:63]
    ds_read_b128 v[164:167], v4 offset:28672
    v_mfma_f32_16x16x32_bf16 v[92:95], v[168:171], v[208:211], v[92:95]
    ds_read_b64_tr_b16 v[124:125], v6 offset:32768
    ds_read_b64_tr_b16 v[126:127], v6 offset:33792
    v_mfma_f32_16x16x32_bf16 v[32:35], v[172:175], v[200:203], v[32:35]
    ds_read_b64_tr_b16 v[128:129], v7 offset:32768
    v_mfma_f32_16x16x32_bf16 v[64:67], v[172:175], v[204:207], v[64:67]
    ds_read_b64_tr_b16 v[130:131], v7 offset:33792
    ds_read_b64_tr_b16 v[132:133], v8 offset:32768
    buffer_load_dwordx4 v213, s[8:11], s71 offen offset:1024  lds
    v_mfma_f32_16x16x32_bf16 v[96:99], v[172:175], v[208:211], v[96:99]
    ds_read_b64_tr_b16 v[134:135], v8 offset:33792
    v_mfma_f32_16x16x32_bf16 v[36:39], v[176:179], v[200:203], v[36:39]
    ds_read_b64_tr_b16 v[136:137], v9 offset:32768
    ds_read_b64_tr_b16 v[138:139], v9 offset:33792
    v_mfma_f32_16x16x32_bf16 v[68:71], v[176:179], v[204:207], v[68:71]
    ds_read_b64_tr_b16 v[140:141], v10 offset:32768
    v_mfma_f32_16x16x32_bf16 v[100:103], v[176:179], v[208:211], v[100:103]
    ds_read_b64_tr_b16 v[142:143], v10 offset:33792
    ds_read_b64_tr_b16 v[144:145], v11 offset:32768
    v_mfma_f32_16x16x32_bf16 v[40:43], v[180:183], v[200:203], v[40:43]
    ds_read_b64_tr_b16 v[146:147], v11 offset:33792
    buffer_load_dwordx4 v214, s[8:11], s71 offen offset:2048  lds
    v_mfma_f32_16x16x32_bf16 v[72:75], v[180:183], v[204:207], v[72:75]
    ds_read_b64_tr_b16 v[148:149], v12 offset:32768
    ds_read_b64_tr_b16 v[150:151], v12 offset:33792
    v_mfma_f32_16x16x32_bf16 v[104:107], v[180:183], v[208:211], v[104:107]
    ds_read_b64_tr_b16 v[152:153], v13 offset:32768
    v_mfma_f32_16x16x32_bf16 v[44:47], v[184:187], v[200:203], v[44:47]
    ds_read_b64_tr_b16 v[154:155], v13 offset:33792
    v_mfma_f32_16x16x32_bf16 v[76:79], v[184:187], v[204:207], v[76:79]
    buffer_load_dwordx4 v215, s[8:11], s71 offen offset:3072  lds
    v_mfma_f32_16x16x32_bf16 v[108:111], v[184:187], v[208:211], v[108:111]
    v_mfma_f32_16x16x32_bf16 v[48:51], v[188:191], v[200:203], v[48:51]
    v_mfma_f32_16x16x32_bf16 v[80:83], v[188:191], v[204:207], v[80:83]
    v_mfma_f32_16x16x32_bf16 v[112:115], v[188:191], v[208:211], v[112:115]
    v_mfma_f32_16x16x32_bf16 v[52:55], v[192:195], v[200:203], v[52:55]
    s_add_u32 m0, s59, 118784
    s_add_u32 s71, s71, 40960
    buffer_load_dwordx4 v212, s[8:11], s71 offen offset:0  lds
    v_mfma_f32_16x16x32_bf16 v[84:87], v[192:195], v[204:207], v[84:87]
    v_mfma_f32_16x16x32_bf16 v[116:119], v[192:195], v[208:211], v[116:119]
    v_mfma_f32_16x16x32_bf16 v[56:59], v[196:199], v[200:203], v[56:59]
    v_mfma_f32_16x16x32_bf16 v[88:91], v[196:199], v[204:207], v[88:91]
    v_mfma_f32_16x16x32_bf16 v[120:123], v[196:199], v[208:211], v[120:123]
    s_waitcnt lgkmcnt(0)
    v_mfma_f32_16x16x32_bf16 v[28:31], v[124:127], v[156:159], v[28:31]
    ds_read_b128 v[200:203], v5 offset:24576
    ds_read_b128 v[204:207], v5 offset:26624
    buffer_load_dwordx4 v213, s[8:11], s71 offen offset:1024  lds
    v_mfma_f32_16x16x32_bf16 v[60:63], v[124:127], v[160:163], v[60:63]
    ds_read_b128 v[208:211], v5 offset:28672
    v_mfma_f32_16x16x32_bf16 v[92:95], v[124:127], v[164:167], v[92:95]
    ds_read_b64_tr_b16 v[168:169], v6 offset:40960
    ds_read_b64_tr_b16 v[170:171], v6 offset:41984
    v_mfma_f32_16x16x32_bf16 v[32:35], v[128:131], v[156:159], v[32:35]
    ds_read_b64_tr_b16 v[172:173], v7 offset:40960
    v_mfma_f32_16x16x32_bf16 v[64:67], v[128:131], v[160:163], v[64:67]
    ds_read_b64_tr_b16 v[174:175], v7 offset:41984
    ds_read_b64_tr_b16 v[176:177], v8 offset:40960
    s_add_u32 m0, s57, 40960
    s_add_u32 s58, s46, 5
    s_lshl_b32 s70, s58, 19
    s_lshl_b32 s75, s58, 7
    buffer_load_dwordx4 v216, s[12:15], s70 offen offset:0  lds
    v_mfma_f32_16x16x32_bf16 v[96:99], v[128:131], v[164:167], v[96:99]
    ds_read_b64_tr_b16 v[178:179], v8 offset:41984
    v_mfma_f32_16x16x32_bf16 v[36:39], v[132:135], v[156:159], v[36:39]
    ds_read_b64_tr_b16 v[180:181], v9 offset:40960
    ds_read_b64_tr_b16 v[182:183], v9 offset:41984
    v_mfma_f32_16x16x32_bf16 v[68:71], v[132:135], v[160:163], v[68:71]
    ds_read_b64_tr_b16 v[184:185], v10 offset:40960
    v_mfma_f32_16x16x32_bf16 v[100:103], v[132:135], v[164:167], v[100:103]
    ds_read_b64_tr_b16 v[186:187], v10 offset:41984
    ds_read_b64_tr_b16 v[188:189], v11 offset:40960
    buffer_load_dwordx4 v217, s[12:15], s70 offen offset:1024  lds
    v_mfma_f32_16x16x32_bf16 v[40:43], v[136:139], v[156:159], v[40:43]
    ds_read_b64_tr_b16 v[190:191], v11 offset:41984
    v_mfma_f32_16x16x32_bf16 v[72:75], v[136:139], v[160:163], v[72:75]
    ds_read_b64_tr_b16 v[192:193], v12 offset:40960
    ds_read_b64_tr_b16 v[194:195], v12 offset:41984
    v_mfma_f32_16x16x32_bf16 v[104:107], v[136:139], v[164:167], v[104:107]
    ds_read_b64_tr_b16 v[196:197], v13 offset:40960
    v_mfma_f32_16x16x32_bf16 v[44:47], v[140:143], v[156:159], v[44:47]
    ds_read_b64_tr_b16 v[198:199], v13 offset:41984
    s_add_u32 m0, s57, 49152
    s_add_u32 s70, s70, 262144
    buffer_load_dwordx4 v216, s[12:15], s70 offen offset:0  lds
    v_mfma_f32_16x16x32_bf16 v[76:79], v[140:143], v[160:163], v[76:79]
    v_mfma_f32_16x16x32_bf16 v[108:111], v[140:143], v[164:167], v[108:111]
    v_mfma_f32_16x16x32_bf16 v[48:51], v[144:147], v[156:159], v[48:51]
    v_mfma_f32_16x16x32_bf16 v[80:83], v[144:147], v[160:163], v[80:83]
    buffer_load_dwordx4 v217, s[12:15], s70 offen offset:1024  lds
    v_mfma_f32_16x16x32_bf16 v[112:115], v[144:147], v[164:167], v[112:115]
    v_mfma_f32_16x16x32_bf16 v[52:55], v[148:151], v[156:159], v[52:55]
    v_mfma_f32_16x16x32_bf16 v[84:87], v[148:151], v[160:163], v[84:87]
    v_mfma_f32_16x16x32_bf16 v[116:119], v[148:151], v[164:167], v[116:119]
    v_mfma_f32_16x16x32_bf16 v[56:59], v[152:155], v[156:159], v[56:59]
    s_waitcnt lgkmcnt(0)
    v_mfma_f32_16x16x32_bf16 v[88:91], v[152:155], v[160:163], v[88:91]
    s_waitcnt vmcnt(20)
    s_barrier
    v_mfma_f32_16x16x32_bf16 v[120:123], v[152:155], v[164:167], v[120:123]
    v_mfma_f32_16x16x32_bf16 v[28:31], v[168:171], v[200:203], v[28:31]
    ds_read_b128 v[156:159], v2 offset:0
    ds_read_b128 v[160:163], v2 offset:2048
    s_add_u32 m0, s59, 139264
    s_nop 0
    buffer_load_dwordx4 v212, s[8:11], s75 offen offset:0  lds
    v_mfma_f32_16x16x32_bf16 v[60:63], v[168:171], v[204:207], v[60:63]
    ds_read_b128 v[164:167], v2 offset:4096
    v_mfma_f32_16x16x32_bf16 v[92:95], v[168:171], v[208:211], v[92:95]
    ds_read_b64_tr_b16 v[124:125], v6 offset:49152
    ds_read_b64_tr_b16 v[126:127], v6 offset:50176
    v_mfma_f32_16x16x32_bf16 v[32:35], v[172:175], v[200:203], v[32:35]
    ds_read_b64_tr_b16 v[128:129], v7 offset:49152
    v_mfma_f32_16x16x32_bf16 v[64:67], v[172:175], v[204:207], v[64:67]
    ds_read_b64_tr_b16 v[130:131], v7 offset:50176
    ds_read_b64_tr_b16 v[132:133], v8 offset:49152
    buffer_load_dwordx4 v213, s[8:11], s75 offen offset:1024  lds
    v_mfma_f32_16x16x32_bf16 v[96:99], v[172:175], v[208:211], v[96:99]
    ds_read_b64_tr_b16 v[134:135], v8 offset:50176
    v_mfma_f32_16x16x32_bf16 v[36:39], v[176:179], v[200:203], v[36:39]
    ds_read_b64_tr_b16 v[136:137], v9 offset:49152
    ds_read_b64_tr_b16 v[138:139], v9 offset:50176
    v_mfma_f32_16x16x32_bf16 v[68:71], v[176:179], v[204:207], v[68:71]
    ds_read_b64_tr_b16 v[140:141], v10 offset:49152
    v_mfma_f32_16x16x32_bf16 v[100:103], v[176:179], v[208:211], v[100:103]
    ds_read_b64_tr_b16 v[142:143], v10 offset:50176
    ds_read_b64_tr_b16 v[144:145], v11 offset:49152
    v_mfma_f32_16x16x32_bf16 v[40:43], v[180:183], v[200:203], v[40:43]
    ds_read_b64_tr_b16 v[146:147], v11 offset:50176
    buffer_load_dwordx4 v214, s[8:11], s75 offen offset:2048  lds
    v_mfma_f32_16x16x32_bf16 v[72:75], v[180:183], v[204:207], v[72:75]
    ds_read_b64_tr_b16 v[148:149], v12 offset:49152
    ds_read_b64_tr_b16 v[150:151], v12 offset:50176
    v_mfma_f32_16x16x32_bf16 v[104:107], v[180:183], v[208:211], v[104:107]
    ds_read_b64_tr_b16 v[152:153], v13 offset:49152
    v_mfma_f32_16x16x32_bf16 v[44:47], v[184:187], v[200:203], v[44:47]
    ds_read_b64_tr_b16 v[154:155], v13 offset:50176
    v_mfma_f32_16x16x32_bf16 v[76:79], v[184:187], v[204:207], v[76:79]
    buffer_load_dwordx4 v215, s[8:11], s75 offen offset:3072  lds
    v_mfma_f32_16x16x32_bf16 v[108:111], v[184:187], v[208:211], v[108:111]
    v_mfma_f32_16x16x32_bf16 v[48:51], v[188:191], v[200:203], v[48:51]
    v_mfma_f32_16x16x32_bf16 v[80:83], v[188:191], v[204:207], v[80:83]
    v_mfma_f32_16x16x32_bf16 v[112:115], v[188:191], v[208:211], v[112:115]
    v_mfma_f32_16x16x32_bf16 v[52:55], v[192:195], v[200:203], v[52:55]
    s_add_u32 m0, s59, 143360
    s_add_u32 s75, s75, 40960
    buffer_load_dwordx4 v212, s[8:11], s75 offen offset:0  lds
    v_mfma_f32_16x16x32_bf16 v[84:87], v[192:195], v[204:207], v[84:87]
    v_mfma_f32_16x16x32_bf16 v[116:119], v[192:195], v[208:211], v[116:119]
    v_mfma_f32_16x16x32_bf16 v[56:59], v[196:199], v[200:203], v[56:59]
    v_mfma_f32_16x16x32_bf16 v[88:91], v[196:199], v[204:207], v[88:91]
    v_mfma_f32_16x16x32_bf16 v[120:123], v[196:199], v[208:211], v[120:123]
    s_waitcnt lgkmcnt(0)
    v_mfma_f32_16x16x32_bf16 v[28:31], v[124:127], v[156:159], v[28:31]
    ds_read_b128 v[200:203], v3 offset:0
    ds_read_b128 v[204:207], v3 offset:2048
    buffer_load_dwordx4 v213, s[8:11], s75 offen offset:1024  lds
    v_mfma_f32_16x16x32_bf16 v[60:63], v[124:127], v[160:163], v[60:63]
    ds_read_b128 v[208:211], v3 offset:4096
    v_mfma_f32_16x16x32_bf16 v[92:95], v[124:127], v[164:167], v[92:95]
    ds_read_b64_tr_b16 v[168:169], v6 offset:57344
    ds_read_b64_tr_b16 v[170:171], v6 offset:58368
    v_mfma_f32_16x16x32_bf16 v[32:35], v[128:131], v[156:159], v[32:35]
    ds_read_b64_tr_b16 v[172:173], v7 offset:57344
    v_mfma_f32_16x16x32_bf16 v[64:67], v[128:131], v[160:163], v[64:67]
    ds_read_b64_tr_b16 v[174:175], v7 offset:58368
    ds_read_b64_tr_b16 v[176:177], v8 offset:57344
    s_add_u32 m0, s57, 57344
    s_add_u32 s58, s46, 6
    s_cmp_ge_u32 s58, 10
    s_cselect_b32 s3, 5, 0
    s_sub_u32 s58, s58, s3
    s_lshl_b32 s70, s58, 19
    s_lshl_b32 s100, s58, 7
    buffer_load_dwordx4 v216, s[12:15], s70 offen offset:0  lds
    v_mfma_f32_16x16x32_bf16 v[96:99], v[128:131], v[164:167], v[96:99]
    ds_read_b64_tr_b16 v[178:179], v8 offset:58368
    v_mfma_f32_16x16x32_bf16 v[36:39], v[132:135], v[156:159], v[36:39]
    ds_read_b64_tr_b16 v[180:181], v9 offset:57344
    ds_read_b64_tr_b16 v[182:183], v9 offset:58368
    v_mfma_f32_16x16x32_bf16 v[68:71], v[132:135], v[160:163], v[68:71]
    ds_read_b64_tr_b16 v[184:185], v10 offset:57344
    v_mfma_f32_16x16x32_bf16 v[100:103], v[132:135], v[164:167], v[100:103]
    ds_read_b64_tr_b16 v[186:187], v10 offset:58368
    ds_read_b64_tr_b16 v[188:189], v11 offset:57344
    buffer_load_dwordx4 v217, s[12:15], s70 offen offset:1024  lds
    v_mfma_f32_16x16x32_bf16 v[40:43], v[136:139], v[156:159], v[40:43]
    ds_read_b64_tr_b16 v[190:191], v11 offset:58368
    v_mfma_f32_16x16x32_bf16 v[72:75], v[136:139], v[160:163], v[72:75]
    ds_read_b64_tr_b16 v[192:193], v12 offset:57344
    ds_read_b64_tr_b16 v[194:195], v12 offset:58368
    v_mfma_f32_16x16x32_bf16 v[104:107], v[136:139], v[164:167], v[104:107]
    ds_read_b64_tr_b16 v[196:197], v13 offset:57344
    v_mfma_f32_16x16x32_bf16 v[44:47], v[140:143], v[156:159], v[44:47]
    ds_read_b64_tr_b16 v[198:199], v13 offset:58368
    s_add_u32 m0, s57, 65536
    s_add_u32 s70, s70, 262144
    buffer_load_dwordx4 v216, s[12:15], s70 offen offset:0  lds
    v_mfma_f32_16x16x32_bf16 v[76:79], v[140:143], v[160:163], v[76:79]
    v_mfma_f32_16x16x32_bf16 v[108:111], v[140:143], v[164:167], v[108:111]
    v_mfma_f32_16x16x32_bf16 v[48:51], v[144:147], v[156:159], v[48:51]
    v_mfma_f32_16x16x32_bf16 v[80:83], v[144:147], v[160:163], v[80:83]
    buffer_load_dwordx4 v217, s[12:15], s70 offen offset:1024  lds
    v_mfma_f32_16x16x32_bf16 v[112:115], v[144:147], v[164:167], v[112:115]
    v_mfma_f32_16x16x32_bf16 v[52:55], v[148:151], v[156:159], v[52:55]
    v_mfma_f32_16x16x32_bf16 v[84:87], v[148:151], v[160:163], v[84:87]
    v_mfma_f32_16x16x32_bf16 v[116:119], v[148:151], v[164:167], v[116:119]
    v_mfma_f32_16x16x32_bf16 v[56:59], v[152:155], v[156:159], v[56:59]
    s_waitcnt lgkmcnt(0)
    v_mfma_f32_16x16x32_bf16 v[88:91], v[152:155], v[160:163], v[88:91]
    s_waitcnt vmcnt(14)
    s_barrier
    v_mfma_f32_16x16x32_bf16 v[120:123], v[152:155], v[164:167], v[120:123]
    v_mfma_f32_16x16x32_bf16 v[28:31], v[168:171], v[200:203], v[28:31]
    ds_read_b128 v[156:159], v4 offset:0
    ds_read_b128 v[160:163], v4 offset:2048
    s_add_u32 m0, s59, 0
    s_nop 0
    buffer_load_dwordx4 v212, s[8:11], s100 offen offset:0  lds
    v_mfma_f32_16x16x32_bf16 v[60:63], v[168:171], v[204:207], v[60:63]
    ds_read_b128 v[164:167], v4 offset:4096
    v_mfma_f32_16x16x32_bf16 v[92:95], v[168:171], v[208:211], v[92:95]
    ds_read_b64_tr_b16 v[124:125], v6 offset:0
    ds_read_b64_tr_b16 v[126:127], v6 offset:1024
    v_mfma_f32_16x16x32_bf16 v[32:35], v[172:175], v[200:203], v[32:35]
    ds_read_b64_tr_b16 v[128:129], v7 offset:0
    v_mfma_f32_16x16x32_bf16 v[64:67], v[172:175], v[204:207], v[64:67]
    ds_read_b64_tr_b16 v[130:131], v7 offset:1024
    ds_read_b64_tr_b16 v[132:133], v8 offset:0
    buffer_load_dwordx4 v213, s[8:11], s100 offen offset:1024  lds
    v_mfma_f32_16x16x32_bf16 v[96:99], v[172:175], v[208:211], v[96:99]
    ds_read_b64_tr_b16 v[134:135], v8 offset:1024
    v_mfma_f32_16x16x32_bf16 v[36:39], v[176:179], v[200:203], v[36:39]
    ds_read_b64_tr_b16 v[136:137], v9 offset:0
    ds_read_b64_tr_b16 v[138:139], v9 offset:1024
    v_mfma_f32_16x16x32_bf16 v[68:71], v[176:179], v[204:207], v[68:71]
    ds_read_b64_tr_b16 v[140:141], v10 offset:0
    v_mfma_f32_16x16x32_bf16 v[100:103], v[176:179], v[208:211], v[100:103]
    ds_read_b64_tr_b16 v[142:143], v10 offset:1024
    ds_read_b64_tr_b16 v[144:145], v11 offset:0
    v_mfma_f32_16x16x32_bf16 v[40:43], v[180:183], v[200:203], v[40:43]
    ds_read_b64_tr_b16 v[146:147], v11 offset:1024
    buffer_load_dwordx4 v214, s[8:11], s100 offen offset:2048  lds
    v_mfma_f32_16x16x32_bf16 v[72:75], v[180:183], v[204:207], v[72:75]
    ds_read_b64_tr_b16 v[148:149], v12 offset:0
    ds_read_b64_tr_b16 v[150:151], v12 offset:1024
    v_mfma_f32_16x16x32_bf16 v[104:107], v[180:183], v[208:211], v[104:107]
    ds_read_b64_tr_b16 v[152:153], v13 offset:0
    v_mfma_f32_16x16x32_bf16 v[44:47], v[184:187], v[200:203], v[44:47]
    ds_read_b64_tr_b16 v[154:155], v13 offset:1024
    v_mfma_f32_16x16x32_bf16 v[76:79], v[184:187], v[204:207], v[76:79]
    ds_read_b64 a[160:161], v244 offset:0
    ds_read_b64 a[162:163], v245 offset:0
    buffer_load_dwordx4 v215, s[8:11], s100 offen offset:3072  lds
    v_mfma_f32_16x16x32_bf16 v[108:111], v[184:187], v[208:211], v[108:111]
    ds_read_b64 a[164:165], v246 offset:0
    ds_read_b64 a[166:167], v247 offset:0
    v_mfma_f32_16x16x32_bf16 v[48:51], v[188:191], v[200:203], v[48:51]
    ds_read_b64 a[168:169], v248 offset:0
    ds_read_b64 a[170:171], v249 offset:0
    v_mfma_f32_16x16x32_bf16 v[80:83], v[188:191], v[204:207], v[80:83]
    ds_read_b64 a[172:173], v250 offset:0
    ds_read_b64 a[174:175], v251 offset:0
    v_mfma_f32_16x16x32_bf16 v[112:115], v[188:191], v[208:211], v[112:115]
    ds_read_b64 a[176:177], v244 offset:4096
    ds_read_b64 a[178:179], v245 offset:4096
    v_mfma_f32_16x16x32_bf16 v[52:55], v[192:195], v[200:203], v[52:55]
    ds_read_b64 a[180:181], v246 offset:4096
    ds_read_b64 a[182:183], v247 offset:4096
    s_add_u32 m0, s59, 4096
    s_add_u32 s100, s100, 40960
    buffer_load_dwordx4 v212, s[8:11], s100 offen offset:0  lds
    v_mfma_f32_16x16x32_bf16 v[84:87], v[192:195], v[204:207], v[84:87]
    v_mfma_f32_16x16x32_bf16 v[116:119], v[192:195], v[208:211], v[116:119]
    v_mfma_f32_16x16x32_bf16 v[56:59], v[196:199], v[200:203], v[56:59]
    v_mfma_f32_16x16x32_bf16 v[88:91], v[196:199], v[204:207], v[88:91]
    v_mfma_f32_16x16x32_bf16 v[120:123], v[196:199], v[208:211], v[120:123]
    s_waitcnt lgkmcnt(0)
    v_mfma_f32_16x16x32_bf16 v[28:31], v[124:127], v[156:159], v[28:31]
    ds_read_b128 v[200:203], v5 offset:0
    ds_read_b128 v[204:207], v5 offset:2048
    buffer_load_dwordx4 v213, s[8:11], s100 offen offset:1024  lds
    v_mfma_f32_16x16x32_bf16 v[60:63], v[124:127], v[160:163], v[60:63]
    ds_read_b128 v[208:211], v5 offset:4096
    v_mfma_f32_16x16x32_bf16 v[92:95], v[124:127], v[164:167], v[92:95]
    ds_read_b64_tr_b16 v[168:169], v6 offset:8192
    ds_read_b64_tr_b16 v[170:171], v6 offset:9216
    v_mfma_f32_16x16x32_bf16 v[32:35], v[128:131], v[156:159], v[32:35]
    ds_read_b64_tr_b16 v[172:173], v7 offset:8192
    v_mfma_f32_16x16x32_bf16 v[64:67], v[128:131], v[160:163], v[64:67]
    ds_read_b64_tr_b16 v[174:175], v7 offset:9216
    ds_read_b64_tr_b16 v[176:177], v8 offset:8192
    s_add_u32 m0, s57, 73728
    s_add_u32 s58, s46, 7
    s_cmp_ge_u32 s58, 10
    s_cselect_b32 s3, 5, 0
    s_sub_u32 s58, s58, s3
    s_lshl_b32 s70, s58, 19
    s_lshl_b32 s101, s58, 7
    buffer_load_dwordx4 v216, s[12:15], s70 offen offset:0  lds
    v_mfma_f32_16x16x32_bf16 v[96:99], v[128:131], v[164:167], v[96:99]
    ds_read_b64_tr_b16 v[178:179], v8 offset:9216
    v_mfma_f32_16x16x32_bf16 v[36:39], v[132:135], v[156:159], v[36:39]
    ds_read_b64_tr_b16 v[180:181], v9 offset:8192
    ds_read_b64_tr_b16 v[182:183], v9 offset:9216
    v_mfma_f32_16x16x32_bf16 v[68:71], v[132:135], v[160:163], v[68:71]
    ds_read_b64_tr_b16 v[184:185], v10 offset:8192
    v_mfma_f32_16x16x32_bf16 v[100:103], v[132:135], v[164:167], v[100:103]
    ds_read_b64_tr_b16 v[186:187], v10 offset:9216
    ds_read_b64_tr_b16 v[188:189], v11 offset:8192
    buffer_load_dwordx4 v217, s[12:15], s70 offen offset:1024  lds
    v_mfma_f32_16x16x32_bf16 v[40:43], v[136:139], v[156:159], v[40:43]
    ds_read_b64_tr_b16 v[190:191], v11 offset:9216
    v_mfma_f32_16x16x32_bf16 v[72:75], v[136:139], v[160:163], v[72:75]
    ds_read_b64_tr_b16 v[192:193], v12 offset:8192
    ds_read_b64_tr_b16 v[194:195], v12 offset:9216
    v_mfma_f32_16x16x32_bf16 v[104:107], v[136:139], v[164:167], v[104:107]
    ds_read_b64_tr_b16 v[196:197], v13 offset:8192
    v_mfma_f32_16x16x32_bf16 v[44:47], v[140:143], v[156:159], v[44:47]
    ds_read_b64_tr_b16 v[198:199], v13 offset:9216
    s_add_u32 m0, s57, 81920
    s_add_u32 s70, s70, 262144
    buffer_load_dwordx4 v216, s[12:15], s70 offen offset:0  lds
    v_mfma_f32_16x16x32_bf16 v[76:79], v[140:143], v[160:163], v[76:79]
    ds_read_b64 a[184:185], v248 offset:4096
    ds_read_b64 a[186:187], v249 offset:4096
    v_mfma_f32_16x16x32_bf16 v[108:111], v[140:143], v[164:167], v[108:111]
    ds_read_b64 a[188:189], v250 offset:4096
    ds_read_b64 a[190:191], v251 offset:4096
    v_mfma_f32_16x16x32_bf16 v[48:51], v[144:147], v[156:159], v[48:51]
    ds_read_b64 a[192:193], v244 offset:8192
    ds_read_b64 a[194:195], v245 offset:8192
    v_mfma_f32_16x16x32_bf16 v[80:83], v[144:147], v[160:163], v[80:83]
    ds_read_b64 a[196:197], v246 offset:8192
    ds_read_b64 a[198:199], v247 offset:8192
    buffer_load_dwordx4 v217, s[12:15], s70 offen offset:1024  lds
    v_mfma_f32_16x16x32_bf16 v[112:115], v[144:147], v[164:167], v[112:115]
    ds_read_b64 a[200:201], v248 offset:8192
    ds_read_b64 a[202:203], v249 offset:8192
    v_mfma_f32_16x16x32_bf16 v[52:55], v[148:151], v[156:159], v[52:55]
    ds_read_b64 a[204:205], v250 offset:8192
    ds_read_b64 a[206:207], v251 offset:8192
    v_mfma_f32_16x16x32_bf16 v[84:87], v[148:151], v[160:163], v[84:87]
    v_mfma_f32_16x16x32_bf16 v[116:119], v[148:151], v[164:167], v[116:119]
    v_mfma_f32_16x16x32_bf16 v[56:59], v[152:155], v[156:159], v[56:59]
    s_waitcnt lgkmcnt(0)
    v_mfma_f32_16x16x32_bf16 v[88:91], v[152:155], v[160:163], v[88:91]
    s_waitcnt vmcnt(14)
    s_barrier
    v_mfma_f32_16x16x32_bf16 v[120:123], v[152:155], v[164:167], v[120:123]
    v_mfma_f32_16x16x32_bf16 v[28:31], v[168:171], v[200:203], v[28:31]
    ds_read_b128 v[156:159], v4 offset:24576
    ds_read_b128 v[160:163], v4 offset:26624
    s_add_u32 m0, s59, 114688
    s_nop 0
    buffer_load_dwordx4 v212, s[8:11], s101 offen offset:0  lds
    v_mfma_f32_16x16x32_bf16 v[60:63], v[168:171], v[204:207], v[60:63]
    ds_read_b128 v[164:167], v4 offset:28672
    v_mfma_f32_16x16x32_bf16 v[92:95], v[168:171], v[208:211], v[92:95]
    ds_read_b64_tr_b16 v[124:125], v6 offset:16384
    ds_read_b64_tr_b16 v[126:127], v6 offset:17408
    v_mfma_f32_16x16x32_bf16 v[32:35], v[172:175], v[200:203], v[32:35]
    ds_read_b64_tr_b16 v[128:129], v7 offset:16384
    v_mfma_f32_16x16x32_bf16 v[64:67], v[172:175], v[204:207], v[64:67]
    ds_read_b64_tr_b16 v[130:131], v7 offset:17408
    ds_read_b64_tr_b16 v[132:133], v8 offset:16384
    buffer_load_dwordx4 v213, s[8:11], s101 offen offset:1024  lds
    v_mfma_f32_16x16x32_bf16 v[96:99], v[172:175], v[208:211], v[96:99]
    ds_read_b64_tr_b16 v[134:135], v8 offset:17408
    v_mfma_f32_16x16x32_bf16 v[36:39], v[176:179], v[200:203], v[36:39]
    ds_read_b64_tr_b16 v[136:137], v9 offset:16384
    ds_read_b64_tr_b16 v[138:139], v9 offset:17408
    v_mfma_f32_16x16x32_bf16 v[68:71], v[176:179], v[204:207], v[68:71]
    ds_read_b64_tr_b16 v[140:141], v10 offset:16384
    v_mfma_f32_16x16x32_bf16 v[100:103], v[176:179], v[208:211], v[100:103]
    ds_read_b64_tr_b16 v[142:143], v10 offset:17408
    ds_read_b64_tr_b16 v[144:145], v11 offset:16384
    v_mfma_f32_16x16x32_bf16 v[40:43], v[180:183], v[200:203], v[40:43]
    ds_read_b64_tr_b16 v[146:147], v11 offset:17408
    buffer_load_dwordx4 v214, s[8:11], s101 offen offset:2048  lds
    v_mfma_f32_16x16x32_bf16 v[72:75], v[180:183], v[204:207], v[72:75]
    ds_read_b64_tr_b16 v[148:149], v12 offset:16384
    ds_read_b64_tr_b16 v[150:151], v12 offset:17408
    v_mfma_f32_16x16x32_bf16 v[104:107], v[180:183], v[208:211], v[104:107]
    ds_read_b64_tr_b16 v[152:153], v13 offset:16384
    v_mfma_f32_16x16x32_bf16 v[44:47], v[184:187], v[200:203], v[44:47]
    ds_read_b64_tr_b16 v[154:155], v13 offset:17408
    v_mfma_f32_16x16x32_bf16 v[76:79], v[184:187], v[204:207], v[76:79]
    buffer_load_dwordx4 v215, s[8:11], s101 offen offset:3072  lds
    v_mfma_f32_16x16x32_bf16 v[108:111], v[184:187], v[208:211], v[108:111]
    v_mfma_f32_16x16x32_bf16 v[48:51], v[188:191], v[200:203], v[48:51]
    v_mfma_f32_16x16x32_bf16 v[80:83], v[188:191], v[204:207], v[80:83]
    v_mfma_f32_16x16x32_bf16 v[112:115], v[188:191], v[208:211], v[112:115]
    v_mfma_f32_16x16x32_bf16 v[52:55], v[192:195], v[200:203], v[52:55]
    s_add_u32 m0, s59, 118784
    s_add_u32 s101, s101, 40960
    buffer_load_dwordx4 v212, s[8:11], s101 offen offset:0  lds
    v_mfma_f32_16x16x32_bf16 v[84:87], v[192:195], v[204:207], v[84:87]
    v_mfma_f32_16x16x32_bf16 v[116:119], v[192:195], v[208:211], v[116:119]
    v_mfma_f32_16x16x32_bf16 v[56:59], v[196:199], v[200:203], v[56:59]
    v_mfma_f32_16x16x32_bf16 v[88:91], v[196:199], v[204:207], v[88:91]
    v_mfma_f32_16x16x32_bf16 v[120:123], v[196:199], v[208:211], v[120:123]
    s_waitcnt lgkmcnt(0)
    v_mfma_f32_16x16x32_bf16 v[28:31], v[124:127], v[156:159], v[28:31]
    ds_read_b128 v[200:203], v5 offset:24576
    ds_read_b128 v[204:207], v5 offset:26624
    buffer_load_dwordx4 v213, s[8:11], s101 offen offset:1024  lds
    v_mfma_f32_16x16x32_bf16 v[60:63], v[124:127], v[160:163], v[60:63]
    ds_read_b128 v[208:211], v5 offset:28672
    v_mfma_f32_16x16x32_bf16 v[92:95], v[124:127], v[164:167], v[92:95]
    ds_read_b64_tr_b16 v[168:169], v6 offset:24576
    ds_read_b64_tr_b16 v[170:171], v6 offset:25600
    v_mfma_f32_16x16x32_bf16 v[32:35], v[128:131], v[156:159], v[32:35]
    ds_read_b64_tr_b16 v[172:173], v7 offset:24576
    v_mfma_f32_16x16x32_bf16 v[64:67], v[128:131], v[160:163], v[64:67]
    ds_read_b64_tr_b16 v[174:175], v7 offset:25600
    ds_read_b64_tr_b16 v[176:177], v8 offset:24576
    s_add_u32 m0, s57, 24576
    s_add_u32 s58, s46, 8
    s_cmp_ge_u32 s58, 10
    s_cselect_b32 s3, 5, 0
    s_sub_u32 s58, s58, s3
    s_lshl_b32 s70, s58, 19
    s_lshl_b32 s71, s58, 7
    buffer_load_dwordx4 v216, s[12:15], s70 offen offset:0  lds
    v_mfma_f32_16x16x32_bf16 v[96:99], v[128:131], v[164:167], v[96:99]
    ds_read_b64_tr_b16 v[178:179], v8 offset:25600
    v_mfma_f32_16x16x32_bf16 v[36:39], v[132:135], v[156:159], v[36:39]
    ds_read_b64_tr_b16 v[180:181], v9 offset:24576
    ds_read_b64_tr_b16 v[182:183], v9 offset:25600
    v_mfma_f32_16x16x32_bf16 v[68:71], v[132:135], v[160:163], v[68:71]
    ds_read_b64_tr_b16 v[184:185], v10 offset:24576
    v_mfma_f32_16x16x32_bf16 v[100:103], v[132:135], v[164:167], v[100:103]
    ds_read_b64_tr_b16 v[186:187], v10 offset:25600
    ds_read_b64_tr_b16 v[188:189], v11 offset:24576
    buffer_load_dwordx4 v217, s[12:15], s70 offen offset:1024  lds
    v_mfma_f32_16x16x32_bf16 v[40:43], v[136:139], v[156:159], v[40:43]
    ds_read_b64_tr_b16 v[190:191], v11 offset:25600
    v_mfma_f32_16x16x32_bf16 v[72:75], v[136:139], v[160:163], v[72:75]
    ds_read_b64_tr_b16 v[192:193], v12 offset:24576
    ds_read_b64_tr_b16 v[194:195], v12 offset:25600
    v_mfma_f32_16x16x32_bf16 v[104:107], v[136:139], v[164:167], v[104:107]
    ds_read_b64_tr_b16 v[196:197], v13 offset:24576
    v_mfma_f32_16x16x32_bf16 v[44:47], v[140:143], v[156:159], v[44:47]
    ds_read_b64_tr_b16 v[198:199], v13 offset:25600
    s_add_u32 m0, s57, 32768
    s_add_u32 s70, s70, 262144
    buffer_load_dwordx4 v216, s[12:15], s70 offen offset:0  lds
    v_mfma_f32_16x16x32_bf16 v[76:79], v[140:143], v[160:163], v[76:79]
    v_mfma_f32_16x16x32_bf16 v[108:111], v[140:143], v[164:167], v[108:111]
    v_mfma_f32_16x16x32_bf16 v[48:51], v[144:147], v[156:159], v[48:51]
    v_mfma_f32_16x16x32_bf16 v[80:83], v[144:147], v[160:163], v[80:83]
    buffer_load_dwordx4 v217, s[12:15], s70 offen offset:1024  lds
    v_mfma_f32_16x16x32_bf16 v[112:115], v[144:147], v[164:167], v[112:115]
    v_mfma_f32_16x16x32_bf16 v[52:55], v[148:151], v[156:159], v[52:55]
    v_mfma_f32_16x16x32_bf16 v[84:87], v[148:151], v[160:163], v[84:87]
    v_mfma_f32_16x16x32_bf16 v[116:119], v[148:151], v[164:167], v[116:119]
    v_mfma_f32_16x16x32_bf16 v[56:59], v[152:155], v[156:159], v[56:59]
    s_waitcnt lgkmcnt(0)
    v_mfma_f32_16x16x32_bf16 v[88:91], v[152:155], v[160:163], v[88:91]
    s_waitcnt vmcnt(14)
    s_barrier
    v_mfma_f32_16x16x32_bf16 v[120:123], v[152:155], v[164:167], v[120:123]
    v_mfma_f32_16x16x32_bf16 v[28:31], v[168:171], v[200:203], v[28:31]
    ds_read_b128 v[156:159], v2 offset:0
    ds_read_b128 v[160:163], v2 offset:2048
    s_add_u32 m0, s59, 139264
    s_nop 0
    buffer_load_dwordx4 v212, s[8:11], s71 offen offset:0  lds
    v_mfma_f32_16x16x32_bf16 v[60:63], v[168:171], v[204:207], v[60:63]
    ds_read_b128 v[164:167], v2 offset:4096
    v_mfma_f32_16x16x32_bf16 v[92:95], v[168:171], v[208:211], v[92:95]
    ds_read_b64_tr_b16 v[124:125], v6 offset:32768
    ds_read_b64_tr_b16 v[126:127], v6 offset:33792
    buffer_load_dwordx4 v213, s[8:11], s71 offen offset:1024  lds
    v_mfma_f32_16x16x32_bf16 v[32:35], v[172:175], v[200:203], v[32:35]
    ds_read_b64_tr_b16 v[128:129], v7 offset:32768
    v_mfma_f32_16x16x32_bf16 v[64:67], v[172:175], v[204:207], v[64:67]
    ds_read_b64_tr_b16 v[130:131], v7 offset:33792
    ds_read_b64_tr_b16 v[132:133], v8 offset:32768
    v_mfma_f32_16x16x32_bf16 v[96:99], v[172:175], v[208:211], v[96:99]
    ds_read_b64_tr_b16 v[134:135], v8 offset:33792
    buffer_load_dwordx4 v214, s[8:11], s71 offen offset:2048  lds
    v_mfma_f32_16x16x32_bf16 v[36:39], v[176:179], v[200:203], v[36:39]
    ds_read_b64_tr_b16 v[136:137], v9 offset:32768
    ds_read_b64_tr_b16 v[138:139], v9 offset:33792
    v_mfma_f32_16x16x32_bf16 v[68:71], v[176:179], v[204:207], v[68:71]
    ds_read_b64_tr_b16 v[140:141], v10 offset:32768
    v_mfma_f32_16x16x32_bf16 v[100:103], v[176:179], v[208:211], v[100:103]
    ds_read_b64_tr_b16 v[142:143], v10 offset:33792
    ds_read_b64_tr_b16 v[144:145], v11 offset:32768
    buffer_load_dwordx4 v215, s[8:11], s71 offen offset:3072  lds
    v_mfma_f32_16x16x32_bf16 v[40:43], v[180:183], v[200:203], v[40:43]
    ds_read_b64_tr_b16 v[146:147], v11 offset:33792
    v_mfma_f32_16x16x32_bf16 v[72:75], v[180:183], v[204:207], v[72:75]
    ds_read_b64_tr_b16 v[148:149], v12 offset:32768
    ds_read_b64_tr_b16 v[150:151], v12 offset:33792
    v_mfma_f32_16x16x32_bf16 v[104:107], v[180:183], v[208:211], v[104:107]
    ds_read_b64_tr_b16 v[152:153], v13 offset:32768
    s_add_u32 m0, s59, 143360
    s_add_u32 s71, s71, 40960
    buffer_load_dwordx4 v212, s[8:11], s71 offen offset:0  lds
    v_mfma_f32_16x16x32_bf16 v[44:47], v[184:187], v[200:203], v[44:47]
    ds_read_b64_tr_b16 v[154:155], v13 offset:33792
    v_mfma_f32_16x16x32_bf16 v[76:79], v[184:187], v[204:207], v[76:79]
    v_mfma_f32_16x16x32_bf16 v[108:111], v[184:187], v[208:211], v[108:111]
    buffer_load_dwordx4 v213, s[8:11], s71 offen offset:1024  lds
    v_mfma_f32_16x16x32_bf16 v[48:51], v[188:191], v[200:203], v[48:51]
    v_mfma_f32_16x16x32_bf16 v[80:83], v[188:191], v[204:207], v[80:83]
    v_mfma_f32_16x16x32_bf16 v[112:115], v[188:191], v[208:211], v[112:115]
    s_add_u32 m0, s57, 40960
    s_add_u32 s58, s46, 9
    s_cmp_ge_u32 s58, 10
    s_cselect_b32 s3, 5, 0
    s_sub_u32 s58, s58, s3
    s_lshl_b32 s70, s58, 19
    s_lshl_b32 s75, s58, 7
    buffer_load_dwordx4 v216, s[12:15], s70 offen offset:0  lds
    v_mfma_f32_16x16x32_bf16 v[52:55], v[192:195], v[200:203], v[52:55]
    v_mfma_f32_16x16x32_bf16 v[84:87], v[192:195], v[204:207], v[84:87]
    v_mfma_f32_16x16x32_bf16 v[116:119], v[192:195], v[208:211], v[116:119]
    buffer_load_dwordx4 v217, s[12:15], s70 offen offset:1024  lds
    v_mfma_f32_16x16x32_bf16 v[56:59], v[196:199], v[200:203], v[56:59]
    v_mfma_f32_16x16x32_bf16 v[88:91], v[196:199], v[204:207], v[88:91]
    v_mfma_f32_16x16x32_bf16 v[120:123], v[196:199], v[208:211], v[120:123]
    s_waitcnt lgkmcnt(0)
    v_mfma_f32_16x16x32_bf16 v[28:31], v[124:127], v[156:159], v[28:31]
    ds_read_b128 v[200:203], v3 offset:0
    ds_read_b128 v[204:207], v3 offset:2048
    s_add_u32 m0, s57, 49152
    s_add_u32 s70, s70, 262144
    buffer_load_dwordx4 v216, s[12:15], s70 offen offset:0  lds
    v_mfma_f32_16x16x32_bf16 v[60:63], v[124:127], v[160:163], v[60:63]
    ds_read_b128 v[208:211], v3 offset:4096
    v_mfma_f32_16x16x32_bf16 v[92:95], v[124:127], v[164:167], v[92:95]
    ds_read_b64_tr_b16 v[168:169], v6 offset:40960
    ds_read_b64_tr_b16 v[170:171], v6 offset:41984
    buffer_load_dwordx4 v217, s[12:15], s70 offen offset:1024  lds
    v_mfma_f32_16x16x32_bf16 v[32:35], v[128:131], v[156:159], v[32:35]
    ds_read_b64_tr_b16 v[172:173], v7 offset:40960
    v_mfma_f32_16x16x32_bf16 v[64:67], v[128:131], v[160:163], v[64:67]
    ds_read_b64_tr_b16 v[174:175], v7 offset:41984
    ds_read_b64_tr_b16 v[176:177], v8 offset:40960
    v_mfma_f32_16x16x32_bf16 v[96:99], v[128:131], v[164:167], v[96:99]
    ds_read_b64_tr_b16 v[178:179], v8 offset:41984
    s_add_u32 m0, s59, 90112
    s_add_u32 s68, s43, 12288
    buffer_load_dwordx4 v218, s[16:19], s68 offen offset:0 nt lds
    v_mfma_f32_16x16x32_bf16 v[36:39], v[132:135], v[156:159], v[36:39]
    ds_read_b64_tr_b16 v[180:181], v9 offset:40960
    ds_read_b64_tr_b16 v[182:183], v9 offset:41984
    v_mfma_f32_16x16x32_bf16 v[68:71], v[132:135], v[160:163], v[68:71]
    ds_read_b64_tr_b16 v[184:185], v10 offset:40960
    buffer_load_dwordx4 v219, s[16:19], s68 offen offset:1024 nt lds
    v_mfma_f32_16x16x32_bf16 v[100:103], v[132:135], v[164:167], v[100:103]
    ds_read_b64_tr_b16 v[186:187], v10 offset:41984
    ds_read_b64_tr_b16 v[188:189], v11 offset:40960
    v_mfma_f32_16x16x32_bf16 v[40:43], v[136:139], v[156:159], v[40:43]
    ds_read_b64_tr_b16 v[190:191], v11 offset:41984
    v_mfma_f32_16x16x32_bf16 v[72:75], v[136:139], v[160:163], v[72:75]
    ds_read_b64_tr_b16 v[192:193], v12 offset:40960
    ds_read_b64_tr_b16 v[194:195], v12 offset:41984
    buffer_load_dwordx4 v220, s[16:19], s68 offen offset:2048 nt lds
    v_mfma_f32_16x16x32_bf16 v[104:107], v[136:139], v[164:167], v[104:107]
    ds_read_b64_tr_b16 v[196:197], v13 offset:40960
    v_mfma_f32_16x16x32_bf16 v[44:47], v[140:143], v[156:159], v[44:47]
    ds_read_b64_tr_b16 v[198:199], v13 offset:41984
    v_mfma_f32_16x16x32_bf16 v[76:79], v[140:143], v[160:163], v[76:79]
    buffer_load_dwordx4 v221, s[16:19], s68 offen offset:3072 nt lds
    v_mfma_f32_16x16x32_bf16 v[108:111], v[140:143], v[164:167], v[108:111]
    v_mfma_f32_16x16x32_bf16 v[48:51], v[144:147], v[156:159], v[48:51]
    s_add_u32 m0, s59, 94208
    s_add_u32 s68, s43, 16384
    buffer_load_dwordx4 v218, s[16:19], s68 offen offset:0 nt lds
    v_mfma_f32_16x16x32_bf16 v[80:83], v[144:147], v[160:163], v[80:83]
    v_mfma_f32_16x16x32_bf16 v[112:115], v[144:147], v[164:167], v[112:115]
    v_mfma_f32_16x16x32_bf16 v[52:55], v[148:151], v[156:159], v[52:55]
    buffer_load_dwordx4 v219, s[16:19], s68 offen offset:1024 nt lds
    v_mfma_f32_16x16x32_bf16 v[84:87], v[148:151], v[160:163], v[84:87]
    v_mfma_f32_16x16x32_bf16 v[116:119], v[148:151], v[164:167], v[116:119]
    v_mfma_f32_16x16x32_bf16 v[56:59], v[152:155], v[156:159], v[56:59]
    s_waitcnt lgkmcnt(0)
    v_mfma_f32_16x16x32_bf16 v[88:91], v[152:155], v[160:163], v[88:91]
    s_waitcnt vmcnt(20)
    s_barrier
    v_mfma_f32_16x16x32_bf16 v[120:123], v[152:155], v[164:167], v[120:123]
    v_mfma_f32_16x16x32_bf16 v[28:31], v[168:171], v[200:203], v[28:31]
    ds_read_b128 v[156:159], v4 offset:0
    ds_read_b128 v[160:163], v4 offset:2048
    s_add_u32 m0, s59, 0
    s_nop 0
    buffer_load_dwordx4 v212, s[8:11], s75 offen offset:0  lds
    v_mfma_f32_16x16x32_bf16 v[60:63], v[168:171], v[204:207], v[60:63]
    ds_read_b128 v[164:167], v4 offset:4096
    v_mfma_f32_16x16x32_bf16 v[92:95], v[168:171], v[208:211], v[92:95]
    ds_read_b64_tr_b16 v[124:125], v6 offset:49152
    ds_read_b64_tr_b16 v[126:127], v6 offset:50176
    v_mfma_f32_16x16x32_bf16 v[32:35], v[172:175], v[200:203], v[32:35]
    ds_read_b64_tr_b16 v[128:129], v7 offset:49152
    v_mfma_f32_16x16x32_bf16 v[64:67], v[172:175], v[204:207], v[64:67]
    ds_read_b64_tr_b16 v[130:131], v7 offset:50176
    ds_read_b64_tr_b16 v[132:133], v8 offset:49152
    buffer_load_dwordx4 v213, s[8:11], s75 offen offset:1024  lds
    v_mfma_f32_16x16x32_bf16 v[96:99], v[172:175], v[208:211], v[96:99]
    ds_read_b64_tr_b16 v[134:135], v8 offset:50176
    v_mfma_f32_16x16x32_bf16 v[36:39], v[176:179], v[200:203], v[36:39]
    ds_read_b64_tr_b16 v[136:137], v9 offset:49152
    ds_read_b64_tr_b16 v[138:139], v9 offset:50176
    v_mfma_f32_16x16x32_bf16 v[68:71], v[176:179], v[204:207], v[68:71]
    ds_read_b64_tr_b16 v[140:141], v10 offset:49152
    v_mfma_f32_16x16x32_bf16 v[100:103], v[176:179], v[208:211], v[100:103]
    ds_read_b64_tr_b16 v[142:143], v10 offset:50176
    ds_read_b64_tr_b16 v[144:145], v11 offset:49152
    v_mfma_f32_16x16x32_bf16 v[40:43], v[180:183], v[200:203], v[40:43]
    ds_read_b64_tr_b16 v[146:147], v11 offset:50176
    buffer_load_dwordx4 v214, s[8:11], s75 offen offset:2048  lds
    v_mfma_f32_16x16x32_bf16 v[72:75], v[180:183], v[204:207], v[72:75]
    ds_read_b64_tr_b16 v[148:149], v12 offset:49152
    ds_read_b64_tr_b16 v[150:151], v12 offset:50176
    v_mfma_f32_16x16x32_bf16 v[104:107], v[180:183], v[208:211], v[104:107]
    ds_read_b64_tr_b16 v[152:153], v13 offset:49152
    v_mfma_f32_16x16x32_bf16 v[44:47], v[184:187], v[200:203], v[44:47]
    ds_read_b64_tr_b16 v[154:155], v13 offset:50176
    v_mfma_f32_16x16x32_bf16 v[76:79], v[184:187], v[204:207], v[76:79]
    buffer_load_dwordx4 v215, s[8:11], s75 offen offset:3072  lds
    v_mfma_f32_16x16x32_bf16 v[108:111], v[184:187], v[208:211], v[108:111]
    v_mfma_f32_16x16x32_bf16 v[48:51], v[188:191], v[200:203], v[48:51]
    v_mfma_f32_16x16x32_bf16 v[80:83], v[188:191], v[204:207], v[80:83]
    v_mfma_f32_16x16x32_bf16 v[112:115], v[188:191], v[208:211], v[112:115]
    v_mfma_f32_16x16x32_bf16 v[52:55], v[192:195], v[200:203], v[52:55]
    s_add_u32 m0, s59, 4096
    s_add_u32 s75, s75, 40960
    buffer_load_dwordx4 v212, s[8:11], s75 offen offset:0  lds
    v_mfma_f32_16x16x32_bf16 v[84:87], v[192:195], v[204:207], v[84:87]
    v_mfma_f32_16x16x32_bf16 v[116:119], v[192:195], v[208:211], v[116:119]
    v_mfma_f32_16x16x32_bf16 v[56:59], v[196:199], v[200:203], v[56:59]
    v_mfma_f32_16x16x32_bf16 v[88:91], v[196:199], v[204:207], v[88:91]
    v_mfma_f32_16x16x32_bf16 v[120:123], v[196:199], v[208:211], v[120:123]
    s_waitcnt lgkmcnt(0)
    v_mfma_f32_16x16x32_bf16 v[28:31], v[124:127], v[156:159], v[28:31]
    ds_read_b128 v[200:203], v5 offset:0
    ds_read_b128 v[204:207], v5 offset:2048
    buffer_load_dwordx4 v213, s[8:11], s75 offen offset:1024  lds
    v_mfma_f32_16x16x32_bf16 v[60:63], v[124:127], v[160:163], v[60:63]
    ds_read_b128 v[208:211], v5 offset:4096
    v_mfma_f32_16x16x32_bf16 v[92:95], v[124:127], v[164:167], v[92:95]
    ds_read_b64_tr_b16 v[168:169], v6 offset:57344
    ds_read_b64_tr_b16 v[170:171], v6 offset:58368
    v_mfma_f32_16x16x32_bf16 v[32:35], v[128:131], v[156:159], v[32:35]
    ds_read_b64_tr_b16 v[172:173], v7 offset:57344
    v_mfma_f32_16x16x32_bf16 v[64:67], v[128:131], v[160:163], v[64:67]
    ds_read_b64_tr_b16 v[174:175], v7 offset:58368
    ds_read_b64_tr_b16 v[176:177], v8 offset:57344
    v_mfma_f32_16x16x32_bf16 v[96:99], v[128:131], v[164:167], v[96:99]
    ds_read_b64_tr_b16 v[178:179], v8 offset:58368
    v_mfma_f32_16x16x32_bf16 v[36:39], v[132:135], v[156:159], v[36:39]
    ds_read_b64_tr_b16 v[180:181], v9 offset:57344
    ds_read_b64_tr_b16 v[182:183], v9 offset:58368
    v_mfma_f32_16x16x32_bf16 v[68:71], v[132:135], v[160:163], v[68:71]
    ds_read_b64_tr_b16 v[184:185], v10 offset:57344
    v_mfma_f32_16x16x32_bf16 v[100:103], v[132:135], v[164:167], v[100:103]
    ds_read_b64_tr_b16 v[186:187], v10 offset:58368
    ds_read_b64_tr_b16 v[188:189], v11 offset:57344
    v_mfma_f32_16x16x32_bf16 v[40:43], v[136:139], v[156:159], v[40:43]
    ds_read_b64_tr_b16 v[190:191], v11 offset:58368
    v_mfma_f32_16x16x32_bf16 v[72:75], v[136:139], v[160:163], v[72:75]
    ds_read_b64_tr_b16 v[192:193], v12 offset:57344
    ds_read_b64_tr_b16 v[194:195], v12 offset:58368
    v_mfma_f32_16x16x32_bf16 v[104:107], v[136:139], v[164:167], v[104:107]
    ds_read_b64_tr_b16 v[196:197], v13 offset:57344
    v_mfma_f32_16x16x32_bf16 v[44:47], v[140:143], v[156:159], v[44:47]
    ds_read_b64_tr_b16 v[198:199], v13 offset:58368
    v_mfma_f32_16x16x32_bf16 v[76:79], v[140:143], v[160:163], v[76:79]
    v_mfma_f32_16x16x32_bf16 v[108:111], v[140:143], v[164:167], v[108:111]
    v_mfma_f32_16x16x32_bf16 v[48:51], v[144:147], v[156:159], v[48:51]
    v_mfma_f32_16x16x32_bf16 v[80:83], v[144:147], v[160:163], v[80:83]
    v_mfma_f32_16x16x32_bf16 v[112:115], v[144:147], v[164:167], v[112:115]
    v_mfma_f32_16x16x32_bf16 v[52:55], v[148:151], v[156:159], v[52:55]
    v_mfma_f32_16x16x32_bf16 v[84:87], v[148:151], v[160:163], v[84:87]
    v_mfma_f32_16x16x32_bf16 v[116:119], v[148:151], v[164:167], v[116:119]
    v_mfma_f32_16x16x32_bf16 v[56:59], v[152:155], v[156:159], v[56:59]
    s_waitcnt lgkmcnt(0)
    v_mfma_f32_16x16x32_bf16 v[88:91], v[152:155], v[160:163], v[88:91]
    s_waitcnt vmcnt(16)
    s_barrier
    v_mfma_f32_16x16x32_bf16 v[120:123], v[152:155], v[164:167], v[120:123]
    v_mfma_f32_16x16x32_bf16 v[28:31], v[168:171], v[200:203], v[28:31]
    ds_read_b128 v[156:159], v4 offset:24576
    ds_read_b128 v[160:163], v4 offset:26624
    s_add_u32 m0, s59, 114688
    s_add_u32 s68, s74, 0
    buffer_load_dwordx4 v222, s[20:23], s68 offen offset:0 nt lds
    v_mfma_f32_16x16x32_bf16 v[60:63], v[168:171], v[204:207], v[60:63]
    ds_read_b128 v[164:167], v4 offset:28672
    v_mfma_f32_16x16x32_bf16 v[92:95], v[168:171], v[208:211], v[92:95]
    ds_read_b64_tr_b16 v[124:125], v6 offset:0
    ds_read_b64_tr_b16 v[126:127], v6 offset:1024
    v_mfma_f32_16x16x32_bf16 v[32:35], v[172:175], v[200:203], v[32:35]
    ds_read_b64_tr_b16 v[128:129], v7 offset:0
    v_mfma_f32_16x16x32_bf16 v[64:67], v[172:175], v[204:207], v[64:67]
    ds_read_b64_tr_b16 v[130:131], v7 offset:1024
    ds_read_b64_tr_b16 v[132:133], v8 offset:0
    v_mfma_f32_16x16x32_bf16 v[96:99], v[172:175], v[208:211], v[96:99]
    ds_read_b64_tr_b16 v[134:135], v8 offset:1024
    v_mfma_f32_16x16x32_bf16 v[36:39], v[176:179], v[200:203], v[36:39]
    ds_read_b64_tr_b16 v[136:137], v9 offset:0
    ds_read_b64_tr_b16 v[138:139], v9 offset:1024
    v_mfma_f32_16x16x32_bf16 v[68:71], v[176:179], v[204:207], v[68:71]
    ds_read_b64_tr_b16 v[140:141], v10 offset:0
    buffer_load_dwordx4 v223, s[20:23], s68 offen offset:1024 nt lds
    v_mfma_f32_16x16x32_bf16 v[100:103], v[176:179], v[208:211], v[100:103]
    ds_read_b64_tr_b16 v[142:143], v10 offset:1024
    ds_read_b64_tr_b16 v[144:145], v11 offset:0
    v_mfma_f32_16x16x32_bf16 v[40:43], v[180:183], v[200:203], v[40:43]
    ds_read_b64_tr_b16 v[146:147], v11 offset:1024
    v_mfma_f32_16x16x32_bf16 v[72:75], v[180:183], v[204:207], v[72:75]
    ds_read_b64_tr_b16 v[148:149], v12 offset:0
    ds_read_b64_tr_b16 v[150:151], v12 offset:1024
    v_mfma_f32_16x16x32_bf16 v[104:107], v[180:183], v[208:211], v[104:107]
    ds_read_b64_tr_b16 v[152:153], v13 offset:0
    v_mfma_f32_16x16x32_bf16 v[44:47], v[184:187], v[200:203], v[44:47]
    ds_read_b64_tr_b16 v[154:155], v13 offset:1024
    v_mfma_f32_16x16x32_bf16 v[76:79], v[184:187], v[204:207], v[76:79]
    v_mfma_f32_16x16x32_bf16 v[108:111], v[184:187], v[208:211], v[108:111]
    v_mfma_f32_16x16x32_bf16 v[48:51], v[188:191], v[200:203], v[48:51]
    buffer_load_dwordx4 v222, s[20:23], s68 offen offset:2048 nt lds
    v_mfma_f32_16x16x32_bf16 v[80:83], v[188:191], v[204:207], v[80:83]
    v_mfma_f32_16x16x32_bf16 v[112:115], v[188:191], v[208:211], v[112:115]
    v_mfma_f32_16x16x32_bf16 v[52:55], v[192:195], v[200:203], v[52:55]
    v_mfma_f32_16x16x32_bf16 v[84:87], v[192:195], v[204:207], v[84:87]
    v_mfma_f32_16x16x32_bf16 v[116:119], v[192:195], v[208:211], v[116:119]
    v_mfma_f32_16x16x32_bf16 v[56:59], v[196:199], v[200:203], v[56:59]
    v_mfma_f32_16x16x32_bf16 v[88:91], v[196:199], v[204:207], v[88:91]
    v_mfma_f32_16x16x32_bf16 v[120:123], v[196:199], v[208:211], v[120:123]
    s_waitcnt lgkmcnt(0)
    v_mfma_f32_16x16x32_bf16 v[28:31], v[124:127], v[156:159], v[28:31]
    ds_read_b128 v[200:203], v5 offset:24576
    ds_read_b128 v[204:207], v5 offset:26624
    buffer_load_dwordx4 v223, s[20:23], s68 offen offset:3072 nt lds
    v_mfma_f32_16x16x32_bf16 v[60:63], v[124:127], v[160:163], v[60:63]
    ds_read_b128 v[208:211], v5 offset:28672
    v_mfma_f32_16x16x32_bf16 v[92:95], v[124:127], v[164:167], v[92:95]
    ds_read_b64_tr_b16 v[168:169], v6 offset:8192
    ds_read_b64_tr_b16 v[170:171], v6 offset:9216
    v_mfma_f32_16x16x32_bf16 v[32:35], v[128:131], v[156:159], v[32:35]
    ds_read_b64_tr_b16 v[172:173], v7 offset:8192
    v_mfma_f32_16x16x32_bf16 v[64:67], v[128:131], v[160:163], v[64:67]
    ds_read_b64_tr_b16 v[174:175], v7 offset:9216
    ds_read_b64_tr_b16 v[176:177], v8 offset:8192
    v_mfma_f32_16x16x32_bf16 v[96:99], v[128:131], v[164:167], v[96:99]
    ds_read_b64_tr_b16 v[178:179], v8 offset:9216
    s_add_u32 m0, s59, 118784
    s_add_u32 s68, s74, 4096
    buffer_load_dwordx4 v222, s[20:23], s68 offen offset:0 nt lds
    v_mfma_f32_16x16x32_bf16 v[36:39], v[132:135], v[156:159], v[36:39]
    ds_read_b64_tr_b16 v[180:181], v9 offset:8192
    ds_read_b64_tr_b16 v[182:183], v9 offset:9216
    v_mfma_f32_16x16x32_bf16 v[68:71], v[132:135], v[160:163], v[68:71]
    ds_read_b64_tr_b16 v[184:185], v10 offset:8192
    v_mfma_f32_16x16x32_bf16 v[100:103], v[132:135], v[164:167], v[100:103]
    ds_read_b64_tr_b16 v[186:187], v10 offset:9216
    ds_read_b64_tr_b16 v[188:189], v11 offset:8192
    v_mfma_f32_16x16x32_bf16 v[40:43], v[136:139], v[156:159], v[40:43]
    ds_read_b64_tr_b16 v[190:191], v11 offset:9216
    v_mfma_f32_16x16x32_bf16 v[72:75], v[136:139], v[160:163], v[72:75]
    ds_read_b64_tr_b16 v[192:193], v12 offset:8192
    ds_read_b64_tr_b16 v[194:195], v12 offset:9216
    buffer_load_dwordx4 v223, s[20:23], s68 offen offset:1024 nt lds
    v_mfma_f32_16x16x32_bf16 v[104:107], v[136:139], v[164:167], v[104:107]
    ds_read_b64_tr_b16 v[196:197], v13 offset:8192
    v_mfma_f32_16x16x32_bf16 v[44:47], v[140:143], v[156:159], v[44:47]
    ds_read_b64_tr_b16 v[198:199], v13 offset:9216
    v_mfma_f32_16x16x32_bf16 v[76:79], v[140:143], v[160:163], v[76:79]
    v_mfma_f32_16x16x32_bf16 v[108:111], v[140:143], v[164:167], v[108:111]
    v_mfma_f32_16x16x32_bf16 v[48:51], v[144:147], v[156:159], v[48:51]
    buffer_load_dwordx2 v[22:23], v24, s[32:35], 0 offen sc1
    v_mfma_f32_16x16x32_bf16 v[80:83], v[144:147], v[160:163], v[80:83]
    v_mfma_f32_16x16x32_bf16 v[112:115], v[144:147], v[164:167], v[112:115]
    v_mfma_f32_16x16x32_bf16 v[52:55], v[148:151], v[156:159], v[52:55]
    v_mfma_f32_16x16x32_bf16 v[84:87], v[148:151], v[160:163], v[84:87]
    v_mfma_f32_16x16x32_bf16 v[116:119], v[148:151], v[164:167], v[116:119]
    v_mfma_f32_16x16x32_bf16 v[56:59], v[152:155], v[156:159], v[56:59]
    s_waitcnt lgkmcnt(0)
    v_mfma_f32_16x16x32_bf16 v[88:91], v[152:155], v[160:163], v[88:91]
    s_waitcnt vmcnt(7)
    s_barrier
    v_mfma_f32_16x16x32_bf16 v[120:123], v[152:155], v[164:167], v[120:123]
    v_mfma_f32_16x16x32_bf16 v[28:31], v[168:171], v[200:203], v[28:31]
    ds_read_b128 v[156:159], v2 offset:0
    ds_read_b128 v[160:163], v2 offset:2048
    s_add_u32 m0, s59, 139264
    s_add_u32 s68, s74, 786432
    buffer_load_dwordx4 v222, s[20:23], s68 offen offset:0 nt lds
    v_mfma_f32_16x16x32_bf16 v[60:63], v[168:171], v[204:207], v[60:63]
    ds_read_b128 v[164:167], v2 offset:4096
    v_mfma_f32_16x16x32_bf16 v[92:95], v[168:171], v[208:211], v[92:95]
    ds_read_b64_tr_b16 v[124:125], v6 offset:16384
    ds_read_b64_tr_b16 v[126:127], v6 offset:17408
    v_mfma_f32_16x16x32_bf16 v[32:35], v[172:175], v[200:203], v[32:35]
    ds_read_b64_tr_b16 v[128:129], v7 offset:16384
    v_mfma_f32_16x16x32_bf16 v[64:67], v[172:175], v[204:207], v[64:67]
    ds_read_b64_tr_b16 v[130:131], v7 offset:17408
    ds_read_b64_tr_b16 v[132:133], v8 offset:16384
    v_mfma_f32_16x16x32_bf16 v[96:99], v[172:175], v[208:211], v[96:99]
    ds_read_b64_tr_b16 v[134:135], v8 offset:17408
    v_mfma_f32_16x16x32_bf16 v[36:39], v[176:179], v[200:203], v[36:39]
    ds_read_b64_tr_b16 v[136:137], v9 offset:16384
    ds_read_b64_tr_b16 v[138:139], v9 offset:17408
    v_mfma_f32_16x16x32_bf16 v[68:71], v[176:179], v[204:207], v[68:71]
    ds_read_b64_tr_b16 v[140:141], v10 offset:16384
    buffer_load_dwordx4 v223, s[20:23], s68 offen offset:1024 nt lds
    v_mfma_f32_16x16x32_bf16 v[100:103], v[176:179], v[208:211], v[100:103]
    ds_read_b64_tr_b16 v[142:143], v10 offset:17408
    ds_read_b64_tr_b16 v[144:145], v11 offset:16384
    v_mfma_f32_16x16x32_bf16 v[40:43], v[180:183], v[200:203], v[40:43]
    ds_read_b64_tr_b16 v[146:147], v11 offset:17408
    v_mfma_f32_16x16x32_bf16 v[72:75], v[180:183], v[204:207], v[72:75]
    ds_read_b64_tr_b16 v[148:149], v12 offset:16384
    ds_read_b64_tr_b16 v[150:151], v12 offset:17408
    v_mfma_f32_16x16x32_bf16 v[104:107], v[180:183], v[208:211], v[104:107]
    ds_read_b64_tr_b16 v[152:153], v13 offset:16384
    v_mfma_f32_16x16x32_bf16 v[44:47], v[184:187], v[200:203], v[44:47]
    ds_read_b64_tr_b16 v[154:155], v13 offset:17408
    v_mfma_f32_16x16x32_bf16 v[76:79], v[184:187], v[204:207], v[76:79]
    ds_read_b64 a[208:209], v244 offset:0
    ds_read_b64 a[210:211], v245 offset:0
    v_mfma_f32_16x16x32_bf16 v[108:111], v[184:187], v[208:211], v[108:111]
    ds_read_b64 a[212:213], v246 offset:0
    ds_read_b64 a[214:215], v247 offset:0
    v_mfma_f32_16x16x32_bf16 v[48:51], v[188:191], v[200:203], v[48:51]
    ds_read_b64 a[216:217], v248 offset:0
    ds_read_b64 a[218:219], v249 offset:0
    buffer_load_dwordx4 v222, s[20:23], s68 offen offset:2048 nt lds
    v_mfma_f32_16x16x32_bf16 v[80:83], v[188:191], v[204:207], v[80:83]
    ds_read_b64 a[220:221], v250 offset:0
    ds_read_b64 a[222:223], v251 offset:0
    v_mfma_f32_16x16x32_bf16 v[112:115], v[188:191], v[208:211], v[112:115]
    ds_read_b64 a[224:225], v244 offset:4096
    ds_read_b64 a[226:227], v245 offset:4096
    v_mfma_f32_16x16x32_bf16 v[52:55], v[192:195], v[200:203], v[52:55]
    ds_read_b64 a[228:229], v246 offset:4096
    ds_read_b64 a[230:231], v247 offset:4096
    v_mfma_f32_16x16x32_bf16 v[84:87], v[192:195], v[204:207], v[84:87]
    v_mfma_f32_16x16x32_bf16 v[116:119], v[192:195], v[208:211], v[116:119]
    v_mfma_f32_16x16x32_bf16 v[56:59], v[196:199], v[200:203], v[56:59]
    v_mfma_f32_16x16x32_bf16 v[88:91], v[196:199], v[204:207], v[88:91]
    v_mfma_f32_16x16x32_bf16 v[120:123], v[196:199], v[208:211], v[120:123]
    s_waitcnt lgkmcnt(0)
    v_mfma_f32_16x16x32_bf16 v[28:31], v[124:127], v[156:159], v[28:31]
    ds_read_b128 v[200:203], v3 offset:0
    ds_read_b128 v[204:207], v3 offset:2048
    buffer_load_dwordx4 v223, s[20:23], s68 offen offset:3072 nt lds
    v_mfma_f32_16x16x32_bf16 v[60:63], v[124:127], v[160:163], v[60:63]
    ds_read_b128 v[208:211], v3 offset:4096
    v_mfma_f32_16x16x32_bf16 v[92:95], v[124:127], v[164:167], v[92:95]
    ds_read_b64_tr_b16 v[168:169], v6 offset:24576
    ds_read_b64_tr_b16 v[170:171], v6 offset:25600
    v_mfma_f32_16x16x32_bf16 v[32:35], v[128:131], v[156:159], v[32:35]
    ds_read_b64_tr_b16 v[172:173], v7 offset:24576
    v_mfma_f32_16x16x32_bf16 v[64:67], v[128:131], v[160:163], v[64:67]
    ds_read_b64_tr_b16 v[174:175], v7 offset:25600
    ds_read_b64_tr_b16 v[176:177], v8 offset:24576
    v_mfma_f32_16x16x32_bf16 v[96:99], v[128:131], v[164:167], v[96:99]
    ds_read_b64_tr_b16 v[178:179], v8 offset:25600
    v_mfma_f32_16x16x32_bf16 v[36:39], v[132:135], v[156:159], v[36:39]
    ds_read_b64_tr_b16 v[180:181], v9 offset:24576
    ds_read_b64_tr_b16 v[182:183], v9 offset:25600
    v_mfma_f32_16x16x32_bf16 v[68:71], v[132:135], v[160:163], v[68:71]
    ds_read_b64_tr_b16 v[184:185], v10 offset:24576
    s_add_u32 m0, s59, 143360
    s_add_u32 s68, s74, 790528
    buffer_load_dwordx4 v222, s[20:23], s68 offen offset:0 nt lds
    v_mfma_f32_16x16x32_bf16 v[100:103], v[132:135], v[164:167], v[100:103]
    ds_read_b64_tr_b16 v[186:187], v10 offset:25600
    ds_read_b64_tr_b16 v[188:189], v11 offset:24576
    v_mfma_f32_16x16x32_bf16 v[40:43], v[136:139], v[156:159], v[40:43]
    ds_read_b64_tr_b16 v[190:191], v11 offset:25600
    v_mfma_f32_16x16x32_bf16 v[72:75], v[136:139], v[160:163], v[72:75]
    ds_read_b64_tr_b16 v[192:193], v12 offset:24576
    ds_read_b64_tr_b16 v[194:195], v12 offset:25600
    v_mfma_f32_16x16x32_bf16 v[104:107], v[136:139], v[164:167], v[104:107]
    ds_read_b64_tr_b16 v[196:197], v13 offset:24576
    v_mfma_f32_16x16x32_bf16 v[44:47], v[140:143], v[156:159], v[44:47]
    ds_read_b64_tr_b16 v[198:199], v13 offset:25600
    v_mfma_f32_16x16x32_bf16 v[76:79], v[140:143], v[160:163], v[76:79]
    ds_read_b64 a[232:233], v248 offset:4096
    ds_read_b64 a[234:235], v249 offset:4096
    v_mfma_f32_16x16x32_bf16 v[108:111], v[140:143], v[164:167], v[108:111]
    ds_read_b64 a[236:237], v250 offset:4096
    ds_read_b64 a[238:239], v251 offset:4096
    v_xor_b32 v6, 0, v15
    v_xor_b32 v7, 32, v15
    buffer_load_dwordx4 v223, s[20:23], s68 offen offset:1024 nt lds
    v_mfma_f32_16x16x32_bf16 v[48:51], v[144:147], v[156:159], v[48:51]
    ds_read_b64 a[240:241], v244 offset:8192
    ds_read_b64 a[242:243], v245 offset:8192
    v_xor_b32 v8, 64, v15
    v_xor_b32 v9, 96, v15
    v_mfma_f32_16x16x32_bf16 v[80:83], v[144:147], v[160:163], v[80:83]
    ds_read_b64 a[244:245], v246 offset:8192
    ds_read_b64 a[246:247], v247 offset:8192
    v_xor_b32 v10, 128, v15
    v_xor_b32 v11, 160, v15
    v_mfma_f32_16x16x32_bf16 v[112:115], v[144:147], v[164:167], v[112:115]
    ds_read_b64 a[248:249], v248 offset:8192
    ds_read_b64 a[250:251], v249 offset:8192
    v_xor_b32 v12, 192, v15
    v_xor_b32 v13, 224, v15
    v_mfma_f32_16x16x32_bf16 v[52:55], v[148:151], v[156:159], v[52:55]
    ds_read_b64 a[252:253], v250 offset:8192
    ds_read_b64 a[254:255], v251 offset:8192
    v_mfma_f32_16x16x32_bf16 v[84:87], v[148:151], v[160:163], v[84:87]
    v_mfma_f32_16x16x32_bf16 v[116:119], v[148:151], v[164:167], v[116:119]
    v_mfma_f32_16x16x32_bf16 v[56:59], v[152:155], v[156:159], v[56:59]
    s_waitcnt lgkmcnt(0)
    v_mfma_f32_16x16x32_bf16 v[88:91], v[152:155], v[160:163], v[88:91]
    s_barrier
    v_mfma_f32_16x16x32_bf16 v[120:123], v[152:155], v[164:167], v[120:123]
    v_mov_b32 v124, v224
    v_mov_b32 v125, v225
    v_mov_b32 v126, v226
    v_mov_b32 v127, v227
    v_mfma_f32_16x16x32_bf16 v[28:31], v[168:171], v[200:203], v[28:31]
    s_add_u32 m0, s67, 0
    s_add_u32 s68, s64, 0
    s_and_b32 s68, s68, 15
    s_mul_i32 s68, s68, 40960
    s_add_u32 s68, s68, s66
    buffer_load_dwordx4 v124, s[28:31], s68 offen offset:0  lds
    v_mfma_f32_16x16x32_bf16 v[32:35], v[172:175], v[200:203], v[32:35]
    buffer_load_dwordx4 v125, s[28:31], s68 offen offset:1024  lds
    v_mfma_f32_16x16x32_bf16 v[36:39], v[176:179], v[200:203], v[36:39]
    buffer_load_dwordx4 v126, s[28:31], s68 offen offset:2048  lds
    v_mfma_f32_16x16x32_bf16 v[40:43], v[180:183], v[200:203], v[40:43]
    buffer_load_dwordx4 v127, s[28:31], s68 offen offset:3072  lds
    v_mfma_f32_16x16x32_bf16 v[44:47], v[184:187], v[200:203], v[44:47]
    v_mov_b32 v2, 0x3f803f80
    v_mov_b32 v3, 0x3f803f80
    v_mfma_f32_16x16x32_bf16 v[48:51], v[188:191], v[200:203], v[48:51]
    v_mov_b32 v4, 0x3f803f80
    v_mov_b32 v5, 0x3f803f80
    v_mfma_f32_16x16x32_bf16 v[52:55], v[192:195], v[200:203], v[52:55]
    v_lshlrev_b32 v20, 4, v0
    s_mul_i32 s3, s5, 48
    s_mul_i32 s59, s7, 12
    s_add_u32 s3, s3, s59
    s_mul_i32 s59, s4, 3
    s_add_u32 s3, s3, s59
    s_lshl_b32 s3, s3, 17
    s_lshl_b32 s59, s6, 12
    s_add_u32 s58, s3, s59
    s_add_u32 s59, s58, 0x20000
    s_add_u32 s57, s58, 0x40000
    v_mfma_f32_16x16x32_bf16 v[56:59], v[196:199], v[200:203], v[56:59]
    s_mov_b32 s56, 0x3e0293ee
    s_mov_b32 s44, s56
    s_mov_b32 s45, s56
    v_cvt_pk_bf16_f32 v212, v28, v29
    v_cvt_pk_bf16_f32 v213, v30, v31
    v_mfma_f32_16x16x32_bf16 v[60:63], v[168:171], v[204:207], v[60:63]
    v_cvt_pk_bf16_f32 v214, v32, v33
    v_cvt_pk_bf16_f32 v215, v34, v35
    v_mfma_f32_16x16x32_bf16 v[64:67], v[172:175], v[204:207], v[64:67]
    v_cvt_pk_bf16_f32 v216, v36, v37
    v_cvt_pk_bf16_f32 v217, v38, v39
    v_mfma_f32_16x16x32_bf16 v[68:71], v[176:179], v[204:207], v[68:71]
    v_cvt_pk_bf16_f32 v218, v40, v41
    v_cvt_pk_bf16_f32 v219, v42, v43
    v_mfma_f32_16x16x32_bf16 v[72:75], v[180:183], v[204:207], v[72:75]
    v_cvt_pk_bf16_f32 v220, v44, v45
    v_cvt_pk_bf16_f32 v221, v46, v47
    v_mfma_f32_16x16x32_bf16 v[76:79], v[184:187], v[204:207], v[76:79]
    v_cvt_pk_bf16_f32 v222, v48, v49
    v_cvt_pk_bf16_f32 v223, v50, v51
    v_mfma_f32_16x16x32_bf16 v[80:83], v[188:191], v[204:207], v[80:83]
    v_cvt_pk_bf16_f32 v224, v52, v53
    v_cvt_pk_bf16_f32 v225, v54, v55
    v_mfma_f32_16x16x32_bf16 v[84:87], v[192:195], v[204:207], v[84:87]
    v_cvt_pk_bf16_f32 v226, v56, v57
    v_cvt_pk_bf16_f32 v227, v58, v59
    v_mfma_f32_16x16x32_bf16 v[88:91], v[196:199], v[204:207], v[88:91]
    v_cvt_pk_bf16_f32 v228, v60, v61
    v_cvt_pk_bf16_f32 v229, v62, v63
    v_mfma_f32_16x16x32_bf16 v[92:95], v[168:171], v[208:211], v[92:95]
    v_cvt_pk_bf16_f32 v230, v64, v65
    v_cvt_pk_bf16_f32 v231, v66, v67
    v_mfma_f32_16x16x32_bf16 v[96:99], v[172:175], v[208:211], v[96:99]
    v_cvt_pk_bf16_f32 v232, v68, v69
    v_cvt_pk_bf16_f32 v233, v70, v71
    v_mfma_f32_16x16x32_bf16 v[100:103], v[176:179], v[208:211], v[100:103]
    v_cvt_pk_bf16_f32 v234, v72, v73
    v_cvt_pk_bf16_f32 v235, v74, v75
    v_mfma_f32_16x16x32_bf16 v[104:107], v[180:183], v[208:211], v[104:107]
    v_cvt_pk_bf16_f32 v236, v76, v77
    v_cvt_pk_bf16_f32 v237, v78, v79
    v_mfma_f32_16x16x32_bf16 v[108:111], v[184:187], v[208:211], v[108:111]
    v_cvt_pk_bf16_f32 v238, v80, v81
    v_cvt_pk_bf16_f32 v239, v82, v83
    v_mfma_f32_16x16x32_bf16 v[112:115], v[188:191], v[208:211], v[112:115]
    v_cvt_pk_bf16_f32 v240, v84, v85
    v_cvt_pk_bf16_f32 v241, v86, v87
    v_mfma_f32_16x16x32_bf16 v[116:119], v[192:195], v[208:211], v[116:119]
    v_cvt_pk_bf16_f32 v242, v88, v89
    v_cvt_pk_bf16_f32 v243, v90, v91
    v_mfma_f32_16x16x32_bf16 v[120:123], v[196:199], v[208:211], v[120:123]
    v_mov_b32 v208, v124
    v_mov_b32 v209, v125
    v_mov_b32 v210, v126
    v_mov_b32 v211, v127
    v_cvt_pk_bf16_f32 v244, v92, v93
    v_mfma_f32_16x16x32_bf16 v[28:31], a[160:163], v[212:215], 0
    v_cvt_pk_bf16_f32 v245, v94, v95
    v_cvt_pk_bf16_f32 v246, v96, v97
    v_mfma_f32_16x16x32_bf16 v[32:35], a[176:179], v[212:215], 0
    v_cvt_pk_bf16_f32 v247, v98, v99
    v_cvt_pk_bf16_f32 v248, v100, v101
    v_mfma_f32_16x16x32_bf16 v[28:31], a[164:167], v[216:219], v[28:31]
    v_cvt_pk_bf16_f32 v249, v102, v103
    v_cvt_pk_bf16_f32 v250, v104, v105
    v_mfma_f32_16x16x32_bf16 v[32:35], a[180:183], v[216:219], v[32:35]
    v_cvt_pk_bf16_f32 v251, v106, v107
    v_cvt_pk_bf16_f32 v252, v108, v109
    v_mfma_f32_16x16x32_bf16 v[28:31], a[168:171], v[220:223], v[28:31]
    v_cvt_pk_bf16_f32 v253, v110, v111
    v_cvt_pk_bf16_f32 v254, v112, v113
    v_mfma_f32_16x16x32_bf16 v[32:35], a[184:187], v[220:223], v[32:35]
    v_cvt_pk_bf16_f32 v255, v114, v115
    v_cvt_pk_bf16_f32 v16, v116, v117
    v_mfma_f32_16x16x32_bf16 v[28:31], a[172:175], v[224:227], v[28:31]
    v_cvt_pk_bf16_f32 v17, v118, v119
    v_cvt_pk_bf16_f32 v18, v120, v121
    v_mfma_f32_16x16x32_bf16 v[32:35], a[188:191], v[224:227], v[32:35]
    v_cvt_pk_bf16_f32 v19, v122, v123
    v_mfma_f32_16x16x32_bf16 v[36:39], a[192:195], v[212:215], 0
    v_mfma_f32_16x16x32_bf16 v[40:43], a[208:211], v[212:215], 0
    v_mfma_f32_16x16x32_bf16 v[36:39], a[196:199], v[216:219], v[36:39]
    v_mfma_f32_16x16x32_bf16 v[40:43], a[212:215], v[216:219], v[40:43]
    v_max3_f32 v84, v28, v29, v30
    v_mfma_f32_16x16x32_bf16 v[36:39], a[200:203], v[220:223], v[36:39]
    v_mfma_f32_16x16x32_bf16 v[40:43], a[216:219], v[220:223], v[40:43]
    v_max3_f32 v84, v84, v31, v32
    v_max3_f32 v84, v84, v33, v34
    v_mfma_f32_16x16x32_bf16 v[36:39], a[204:207], v[224:227], v[36:39]
    v_mfma_f32_16x16x32_bf16 v[40:43], a[220:223], v[224:227], v[40:43]
    v_mfma_f32_16x16x32_bf16 v[44:47], a[224:227], v[212:215], 0
    v_mfma_f32_16x16x32_bf16 v[48:51], a[240:243], v[212:215], 0
    v_mfma_f32_16x16x32_bf16 v[44:47], a[228:231], v[216:219], v[44:47]
    v_mfma_f32_16x16x32_bf16 v[48:51], a[244:247], v[216:219], v[48:51]
    v_mfma_f32_16x16x32_bf16 v[44:47], a[232:235], v[220:223], v[44:47]
    v_mfma_f32_16x16x32_bf16 v[48:51], a[248:251], v[220:223], v[48:51]
    v_mfma_f32_16x16x32_bf16 v[44:47], a[236:239], v[224:227], v[44:47]
    v_max3_f32 v84, v84, v35, v36
    v_max3_f32 v84, v84, v37, v38
    v_mfma_f32_16x16x32_bf16 v[48:51], a[252:255], v[224:227], v[48:51]
    v_max3_f32 v84, v84, v39, v40
    v_max3_f32 v84, v84, v41, v42
    v_mfma_f32_16x16x32_bf16 v[60:63], a[160:163], v[228:231], 0
    v_mfma_f32_16x16x32_bf16 v[64:67], a[176:179], v[228:231], 0
    v_mfma_f32_16x16x32_bf16 v[60:63], a[164:167], v[232:235], v[60:63]
    v_max3_f32 v84, v84, v43, v44
    v_max3_f32 v84, v84, v45, v46
    v_mfma_f32_16x16x32_bf16 v[64:67], a[180:183], v[232:235], v[64:67]
    v_max3_f32 v84, v84, v47, v48
    v_max3_f32 v84, v84, v49, v50
    v_mfma_f32_16x16x32_bf16 v[60:63], a[168:171], v[236:239], v[60:63]
    v_max_f32 v84, v84, v51
    v_mov_b32 v85, v84
    v_mfma_f32_16x16x32_bf16 v[64:67], a[184:187], v[236:239], v[64:67]
    v_mfma_f32_16x16x32_bf16 v[60:63], a[172:175], v[240:243], v[60:63]
    v_permlane16_swap_b32 v84, v85
    v_mfma_f32_16x16x32_bf16 v[64:67], a[188:191], v[240:243], v[64:67]
    v_max_f32 v84, v84, v85
    v_mov_b32 v85, v84
    v_mfma_f32_16x16x32_bf16 v[68:71], a[192:195], v[228:231], 0
    v_mfma_f32_16x16x32_bf16 v[72:75], a[208:211], v[228:231], 0
    v_permlane32_swap_b32 v84, v85
    v_mfma_f32_16x16x32_bf16 v[68:71], a[196:199], v[232:235], v[68:71]
    v_max_f32 v84, v84, v85
    v_mul_f32 v84, s56, v84
    v_mfma_f32_16x16x32_bf16 v[72:75], a[212:215], v[232:235], v[72:75]
    v_fma_f32 v28, v28, s56, -v84
    v_fma_f32 v29, v29, s56, -v84
    v_mfma_f32_16x16x32_bf16 v[68:71], a[200:203], v[236:239], v[68:71]
    v_fma_f32 v30, v30, s56, -v84
    v_fma_f32 v31, v31, s56, -v84
    v_mfma_f32_16x16x32_bf16 v[72:75], a[216:219], v[236:239], v[72:75]
    v_exp_f32 v28, v28
    v_mfma_f32_16x16x32_bf16 v[68:71], a[204:207], v[240:243], v[68:71]
    v_exp_f32 v29, v29
    v_mfma_f32_16x16x32_bf16 v[72:75], a[220:223], v[240:243], v[72:75]
    v_exp_f32 v30, v30
    v_mfma_f32_16x16x32_bf16 v[76:79], a[224:227], v[228:231], 0
    v_exp_f32 v31, v31
    v_mfma_f32_16x16x32_bf16 v[80:83], a[240:243], v[228:231], 0
    v_fma_f32 v32, v32, s56, -v84
    v_fma_f32 v33, v33, s56, -v84
    v_mfma_f32_16x16x32_bf16 v[76:79], a[228:231], v[232:235], v[76:79]
    v_fma_f32 v34, v34, s56, -v84
    v_fma_f32 v35, v35, s56, -v84
    v_mfma_f32_16x16x32_bf16 v[80:83], a[244:247], v[232:235], v[80:83]
    v_cvt_pk_bf16_f32 v212, v28, v29
    v_cvt_pk_bf16_f32 v213, v30, v31
    v_mfma_f32_16x16x32_bf16 v[76:79], a[232:235], v[236:239], v[76:79]
    v_exp_f32 v32, v32
    v_mfma_f32_16x16x32_bf16 v[80:83], a[248:251], v[236:239], v[80:83]
    v_exp_f32 v33, v33
    v_mfma_f32_16x16x32_bf16 v[76:79], a[236:239], v[240:243], v[76:79]
    v_exp_f32 v34, v34
    v_mfma_f32_16x16x32_bf16 v[80:83], a[252:255], v[240:243], v[80:83]
    v_exp_f32 v35, v35
    v_mfma_f32_16x16x32_bf16 v[92:95], a[160:163], v[244:247], 0
    v_fma_f32 v36, v36, s56, -v84
    v_fma_f32 v37, v37, s56, -v84
    v_mfma_f32_16x16x32_bf16 v[96:99], a[176:179], v[244:247], 0
    v_fma_f32 v38, v38, s56, -v84
    v_fma_f32 v39, v39, s56, -v84
    v_mfma_f32_16x16x32_bf16 v[92:95], a[164:167], v[248:251], v[92:95]
    v_cvt_pk_bf16_f32 v214, v32, v33
    v_cvt_pk_bf16_f32 v215, v34, v35
    v_mfma_f32_16x16x32_bf16 v[96:99], a[180:183], v[248:251], v[96:99]
    v_exp_f32 v36, v36
    v_mfma_f32_16x16x32_bf16 v[92:95], a[168:171], v[252:255], v[92:95]
    v_exp_f32 v37, v37
    v_mfma_f32_16x16x32_bf16 v[96:99], a[184:187], v[252:255], v[96:99]
    v_exp_f32 v38, v38
    v_mfma_f32_16x16x32_bf16 v[92:95], a[172:175], v[16:19], v[92:95]
    v_exp_f32 v39, v39
    v_mfma_f32_16x16x32_bf16 v[96:99], a[188:191], v[16:19], v[96:99]
    v_fma_f32 v40, v40, s56, -v84
    v_fma_f32 v41, v41, s56, -v84
    v_mfma_f32_16x16x32_bf16 v[100:103], a[192:195], v[244:247], 0
    v_fma_f32 v42, v42, s56, -v84
    v_fma_f32 v43, v43, s56, -v84
    v_mfma_f32_16x16x32_bf16 v[104:107], a[208:211], v[244:247], 0
    v_cvt_pk_bf16_f32 v216, v36, v37
    v_cvt_pk_bf16_f32 v217, v38, v39
    v_mfma_f32_16x16x32_bf16 v[100:103], a[196:199], v[248:251], v[100:103]
    v_exp_f32 v40, v40
    v_mfma_f32_16x16x32_bf16 v[104:107], a[212:215], v[248:251], v[104:107]
    v_exp_f32 v41, v41
    v_mfma_f32_16x16x32_bf16 v[100:103], a[200:203], v[252:255], v[100:103]
    v_exp_f32 v42, v42
    v_mfma_f32_16x16x32_bf16 v[104:107], a[216:219], v[252:255], v[104:107]
    v_exp_f32 v43, v43
    v_mfma_f32_16x16x32_bf16 v[100:103], a[204:207], v[16:19], v[100:103]
    s_waitcnt vmcnt(4)
    s_barrier
    s_add_u32 m0, s67, 16384
    s_add_u32 s68, s64, 1
    s_and_b32 s68, s68, 15
    s_mul_i32 s68, s68, 40960
    s_add_u32 s68, s68, s66
    buffer_load_dwordx4 v208, s[28:31], s68 offen offset:0  lds
    v_mfma_f32_16x16x32_bf16 v[104:107], a[220:223], v[16:19], v[104:107]
    buffer_load_dwordx4 v209, s[28:31], s68 offen offset:1024  lds
    v_mfma_f32_16x16x32_bf16 v[108:111], a[224:227], v[244:247], 0
    buffer_load_dwordx4 v210, s[28:31], s68 offen offset:2048  lds
    v_mfma_f32_16x16x32_bf16 v[112:115], a[240:243], v[244:247], 0
    buffer_load_dwordx4 v211, s[28:31], s68 offen offset:3072  lds
    v_mfma_f32_16x16x32_bf16 v[108:111], a[228:231], v[248:251], v[108:111]
    ds_read_b64_tr_b16 a[64:65], v6 offset:0
    ds_read_b64_tr_b16 a[66:67], v6 offset:4096
    v_mfma_f32_16x16x32_bf16 v[112:115], a[244:247], v[248:251], v[112:115]
    ds_read_b64_tr_b16 a[68:69], v6 offset:8192
    ds_read_b64_tr_b16 a[70:71], v6 offset:12288
    v_mfma_f32_16x16x32_bf16 v[108:111], a[232:235], v[252:255], v[108:111]
    ds_read_b64_tr_b16 a[72:73], v6 offset:16384
    ds_read_b64_tr_b16 a[74:75], v6 offset:20480
    v_mfma_f32_16x16x32_bf16 v[112:115], a[248:251], v[252:255], v[112:115]
    ds_read_b64_tr_b16 a[76:77], v7 offset:0
    ds_read_b64_tr_b16 a[78:79], v7 offset:4096
    v_mfma_f32_16x16x32_bf16 v[108:111], a[236:239], v[16:19], v[108:111]
    ds_read_b64_tr_b16 a[80:81], v7 offset:8192
    ds_read_b64_tr_b16 a[82:83], v7 offset:12288
    v_mfma_f32_16x16x32_bf16 v[112:115], a[252:255], v[16:19], v[112:115]
    ds_read_b64_tr_b16 a[84:85], v7 offset:16384
    ds_read_b64_tr_b16 a[86:87], v7 offset:20480
    ds_read_b64_tr_b16 a[88:89], v8 offset:0
    v_pk_fma_f32 v[44:45], v[44:45], s[44:45], v[84:85] op_sel_hi:[1,1,0] neg_lo:[0,0,1] neg_hi:[0,0,1]
    ds_read_b64_tr_b16 a[90:91], v8 offset:4096
    v_pk_fma_f32 v[46:47], v[46:47], s[44:45], v[84:85] op_sel_hi:[1,1,0] neg_lo:[0,0,1] neg_hi:[0,0,1]
    ds_read_b64_tr_b16 a[92:93], v8 offset:8192
    v_cvt_pk_bf16_f32 v218, v40, v41
    ds_read_b64_tr_b16 a[94:95], v8 offset:12288
    v_cvt_pk_bf16_f32 v219, v42, v43
    ds_read_b64_tr_b16 a[96:97], v8 offset:16384
    v_exp_f32 v44, v44
    ds_read_b64_tr_b16 a[98:99], v8 offset:20480
    v_exp_f32 v45, v45
    ds_read_b64_tr_b16 a[100:101], v9 offset:0
    v_exp_f32 v46, v46
    ds_read_b64_tr_b16 a[102:103], v9 offset:4096
    v_exp_f32 v47, v47
    ds_read_b64_tr_b16 a[104:105], v9 offset:8192
    v_pk_fma_f32 v[48:49], v[48:49], s[44:45], v[84:85] op_sel_hi:[1,1,0] neg_lo:[0,0,1] neg_hi:[0,0,1]
    ds_read_b64_tr_b16 a[106:107], v9 offset:12288
    v_pk_fma_f32 v[50:51], v[50:51], s[44:45], v[84:85] op_sel_hi:[1,1,0] neg_lo:[0,0,1] neg_hi:[0,0,1]
    ds_read_b64_tr_b16 a[108:109], v9 offset:16384
    v_cvt_pk_bf16_f32 v220, v44, v45
    ds_read_b64_tr_b16 a[110:111], v9 offset:20480
    v_cvt_pk_bf16_f32 v221, v46, v47
    ds_read_b64_tr_b16 a[112:113], v10 offset:0
    v_exp_f32 v48, v48
    ds_read_b64_tr_b16 a[114:115], v10 offset:4096
    v_exp_f32 v49, v49
    ds_read_b64_tr_b16 a[116:117], v10 offset:8192
    v_exp_f32 v50, v50
    ds_read_b64_tr_b16 a[118:119], v10 offset:12288
    v_exp_f32 v51, v51
    ds_read_b64_tr_b16 a[120:121], v10 offset:16384
    v_cvt_pk_bf16_f32 v222, v48, v49
    ds_read_b64_tr_b16 a[122:123], v10 offset:20480
    v_cvt_pk_bf16_f32 v223, v50, v51
    ds_read_b64_tr_b16 a[124:125], v11 offset:0
    v_max3_f32 v86, v60, v61, v62
    v_mfma_f32_16x16x32_bf16 v[16:19], v[2:5], v[212:215], 0
    ds_read_b64_tr_b16 a[126:127], v11 offset:4096
    ds_read_b64_tr_b16 a[128:129], v11 offset:8192
    v_mfma_f32_16x16x32_bf16 v[16:19], v[2:5], v[216:219], v[16:19]
    ds_read_b64_tr_b16 a[130:131], v11 offset:12288
    ds_read_b64_tr_b16 a[132:133], v11 offset:16384
    v_mfma_f32_16x16x32_bf16 v[16:19], v[2:5], v[220:223], v[16:19]
    ds_read_b64_tr_b16 a[134:135], v11 offset:20480
    ds_read_b64_tr_b16 a[136:137], v12 offset:0
    s_waitcnt lgkmcnt(14)
    v_mfma_f32_16x16x32_bf16 v[28:31], a[64:67], v[212:215], 0
    ds_read_b64_tr_b16 a[138:139], v12 offset:4096
    ds_read_b64_tr_b16 a[140:141], v12 offset:8192
    v_mfma_f32_16x16x32_bf16 v[32:35], a[76:79], v[212:215], 0
    ds_read_b64_tr_b16 a[142:143], v12 offset:12288
    ds_read_b64_tr_b16 a[144:145], v12 offset:16384
    v_mfma_f32_16x16x32_bf16 v[28:31], a[68:71], v[216:219], v[28:31]
    ds_read_b64_tr_b16 a[146:147], v12 offset:20480
    ds_read_b64_tr_b16 a[148:149], v13 offset:0
    v_mfma_f32_16x16x32_bf16 v[32:35], a[80:83], v[216:219], v[32:35]
    ds_read_b64_tr_b16 a[150:151], v13 offset:4096
    ds_read_b64_tr_b16 a[152:153], v13 offset:8192
    v_mfma_f32_16x16x32_bf16 v[28:31], a[72:75], v[220:223], v[28:31]
    ds_read_b64_tr_b16 a[154:155], v13 offset:12288
    ds_read_b64_tr_b16 a[156:157], v13 offset:16384
    v_mfma_f32_16x16x32_bf16 v[32:35], a[84:87], v[220:223], v[32:35]
    ds_read_b64_tr_b16 a[158:159], v13 offset:20480
    v_rcp_f32 v25, v16
    v_mfma_f32_16x16x32_bf16 v[36:39], a[88:91], v[212:215], 0
    v_max3_f32 v86, v86, v63, v64
    v_max3_f32 v86, v86, v65, v66
    v_mfma_f32_16x16x32_bf16 v[40:43], a[100:103], v[212:215], 0
    v_mul_f32 v28, v28, v25
    v_mul_f32 v29, v29, v25
    v_mfma_f32_16x16x32_bf16 v[36:39], a[92:95], v[216:219], v[36:39]
    v_mul_f32 v30, v30, v25
    v_mul_f32 v31, v31, v25
    v_mfma_f32_16x16x32_bf16 v[40:43], a[104:107], v[216:219], v[40:43]
    v_mul_f32 v32, v32, v25
    v_mul_f32 v33, v33, v25
    v_mfma_f32_16x16x32_bf16 v[36:39], a[96:99], v[220:223], v[36:39]
    v_mul_f32 v34, v34, v25
    v_mul_f32 v35, v35, v25
    s_waitcnt lgkmcnt(14)
    v_mfma_f32_16x16x32_bf16 v[40:43], a[108:111], v[220:223], v[40:43]
    v_cvt_pk_bf16_f32 v28, v28, v29
    v_cvt_pk_bf16_f32 v29, v30, v31
    v_mfma_f32_16x16x32_bf16 v[44:47], a[112:115], v[212:215], 0
    v_cvt_pk_bf16_f32 v30, v32, v33
    v_cvt_pk_bf16_f32 v31, v34, v35
    v_mfma_f32_16x16x32_bf16 v[48:51], a[124:127], v[212:215], 0
    buffer_store_dwordx4 v[28:31], v20, s[24:27], s58 offen offset:0 sc0 sc1
    v_mul_f32 v36, v36, v25
    v_mul_f32 v37, v37, v25
    v_mfma_f32_16x16x32_bf16 v[44:47], a[116:119], v[216:219], v[44:47]
    v_mul_f32 v38, v38, v25
    v_mul_f32 v39, v39, v25
    v_mfma_f32_16x16x32_bf16 v[48:51], a[128:131], v[216:219], v[48:51]
    v_mul_f32 v40, v40, v25
    v_mul_f32 v41, v41, v25
    v_mfma_f32_16x16x32_bf16 v[44:47], a[120:123], v[220:223], v[44:47]
    v_mul_f32 v42, v42, v25
    v_mul_f32 v43, v43, v25
    s_waitcnt lgkmcnt(12)
    v_mfma_f32_16x16x32_bf16 v[48:51], a[132:135], v[220:223], v[48:51]
    v_cvt_pk_bf16_f32 v36, v36, v37
    v_cvt_pk_bf16_f32 v37, v38, v39
    s_waitcnt lgkmcnt(10)
    v_mfma_f32_16x16x32_bf16 v[52:55], a[136:139], v[212:215], 0
    v_cvt_pk_bf16_f32 v38, v40, v41
    v_cvt_pk_bf16_f32 v39, v42, v43
    s_waitcnt lgkmcnt(4)
    v_mfma_f32_16x16x32_bf16 v[56:59], a[148:151], v[212:215], 0
    buffer_store_dwordx4 v[36:39], v20, s[24:27], s58 offen offset:1024 sc0 sc1
    v_mul_f32 v44, v44, v25
    v_mul_f32 v45, v45, v25
    v_mfma_f32_16x16x32_bf16 v[52:55], a[140:143], v[216:219], v[52:55]
    v_mul_f32 v46, v46, v25
    v_mul_f32 v47, v47, v25
    s_waitcnt lgkmcnt(2)
    v_mfma_f32_16x16x32_bf16 v[56:59], a[152:155], v[216:219], v[56:59]
    v_mul_f32 v48, v48, v25
    v_mul_f32 v49, v49, v25
    v_mfma_f32_16x16x32_bf16 v[52:55], a[144:147], v[220:223], v[52:55]
    v_mul_f32 v50, v50, v25
    v_mul_f32 v51, v51, v25
    s_waitcnt lgkmcnt(0)
    v_mfma_f32_16x16x32_bf16 v[56:59], a[156:159], v[220:223], v[56:59]
    v_cvt_pk_bf16_f32 v44, v44, v45
    v_cvt_pk_bf16_f32 v45, v46, v47
    v_cvt_pk_bf16_f32 v46, v48, v49
    v_cvt_pk_bf16_f32 v47, v50, v51
    buffer_store_dwordx4 v[44:47], v20, s[24:27], s58 offen offset:2048 sc0 sc1
    v_pk_mul_f32 v[52:53], v[52:53], v[24:25] op_sel:[0,1] op_sel_hi:[1,1]
    v_pk_mul_f32 v[54:55], v[54:55], v[24:25] op_sel:[0,1] op_sel_hi:[1,1]
    v_max3_f32 v86, v86, v67, v68
    v_pk_mul_f32 v[56:57], v[56:57], v[24:25] op_sel:[0,1] op_sel_hi:[1,1]
    v_pk_mul_f32 v[58:59], v[58:59], v[24:25] op_sel:[0,1] op_sel_hi:[1,1]
    v_cvt_pk_bf16_f32 v52, v52, v53
    v_cvt_pk_bf16_f32 v53, v54, v55
    v_cvt_pk_bf16_f32 v54, v56, v57
    v_cvt_pk_bf16_f32 v55, v58, v59
    buffer_store_dwordx4 v[52:55], v20, s[24:27], s58 offen offset:3072 sc0 sc1
    v_max3_f32 v86, v86, v69, v70
    v_max3_f32 v86, v86, v71, v72
    v_max3_f32 v86, v86, v73, v74
    v_max3_f32 v86, v86, v75, v76
    v_max3_f32 v86, v86, v77, v78
    v_max3_f32 v86, v86, v79, v80
    v_max3_f32 v86, v86, v81, v82
    v_max_f32 v86, v86, v83
    v_mov_b32 v87, v86
    s_nop 1
    v_permlane16_swap_b32 v86, v87
    s_nop 0
    v_max_f32 v86, v86, v87
    v_mov_b32 v87, v86
    s_nop 1
    v_permlane32_swap_b32 v86, v87
    s_nop 0
    v_max_f32 v86, v86, v87
    v_mul_f32 v86, s56, v86
    v_pk_fma_f32 v[60:61], v[60:61], s[44:45], v[86:87] op_sel_hi:[1,1,0] neg_lo:[0,0,1] neg_hi:[0,0,1]
    v_pk_fma_f32 v[62:63], v[62:63], s[44:45], v[86:87] op_sel_hi:[1,1,0] neg_lo:[0,0,1] neg_hi:[0,0,1]
    v_exp_f32 v60, v60
    v_exp_f32 v61, v61
    v_exp_f32 v62, v62
    v_exp_f32 v63, v63
    v_pk_fma_f32 v[64:65], v[64:65], s[44:45], v[86:87] op_sel_hi:[1,1,0] neg_lo:[0,0,1] neg_hi:[0,0,1]
    v_pk_fma_f32 v[66:67], v[66:67], s[44:45], v[86:87] op_sel_hi:[1,1,0] neg_lo:[0,0,1] neg_hi:[0,0,1]
    v_cvt_pk_bf16_f32 v228, v60, v61
    v_cvt_pk_bf16_f32 v229, v62, v63
    v_exp_f32 v64, v64
    v_exp_f32 v65, v65
    v_exp_f32 v66, v66
    v_exp_f32 v67, v67
    v_pk_fma_f32 v[68:69], v[68:69], s[44:45], v[86:87] op_sel_hi:[1,1,0] neg_lo:[0,0,1] neg_hi:[0,0,1]
    v_pk_fma_f32 v[70:71], v[70:71], s[44:45], v[86:87] op_sel_hi:[1,1,0] neg_lo:[0,0,1] neg_hi:[0,0,1]
    v_cvt_pk_bf16_f32 v230, v64, v65
    v_cvt_pk_bf16_f32 v231, v66, v67
    v_exp_f32 v68, v68
    v_exp_f32 v69, v69
    v_exp_f32 v70, v70
    v_exp_f32 v71, v71
    v_pk_fma_f32 v[72:73], v[72:73], s[44:45], v[86:87] op_sel_hi:[1,1,0] neg_lo:[0,0,1] neg_hi:[0,0,1]
    v_pk_fma_f32 v[74:75], v[74:75], s[44:45], v[86:87] op_sel_hi:[1,1,0] neg_lo:[0,0,1] neg_hi:[0,0,1]
    v_cvt_pk_bf16_f32 v232, v68, v69
    v_cvt_pk_bf16_f32 v233, v70, v71
    v_exp_f32 v72, v72
    v_exp_f32 v73, v73
    v_exp_f32 v74, v74
    v_exp_f32 v75, v75
    v_pk_fma_f32 v[76:77], v[76:77], s[44:45], v[86:87] op_sel_hi:[1,1,0] neg_lo:[0,0,1] neg_hi:[0,0,1]
    v_pk_fma_f32 v[78:79], v[78:79], s[44:45], v[86:87] op_sel_hi:[1,1,0] neg_lo:[0,0,1] neg_hi:[0,0,1]
    v_cvt_pk_bf16_f32 v234, v72, v73
    v_cvt_pk_bf16_f32 v235, v74, v75
    v_exp_f32 v76, v76
    v_exp_f32 v77, v77
    v_exp_f32 v78, v78
    v_exp_f32 v79, v79
    v_pk_fma_f32 v[80:81], v[80:81], s[44:45], v[86:87] op_sel_hi:[1,1,0] neg_lo:[0,0,1] neg_hi:[0,0,1]
    v_pk_fma_f32 v[82:83], v[82:83], s[44:45], v[86:87] op_sel_hi:[1,1,0] neg_lo:[0,0,1] neg_hi:[0,0,1]
    v_cvt_pk_bf16_f32 v236, v76, v77
    v_cvt_pk_bf16_f32 v237, v78, v79
    v_exp_f32 v80, v80
    v_exp_f32 v81, v81
    v_exp_f32 v82, v82
    v_exp_f32 v83, v83
    v_cvt_pk_bf16_f32 v238, v80, v81
    v_cvt_pk_bf16_f32 v239, v82, v83
    v_max3_f32 v116, v92, v93, v94
    v_max3_f32 v116, v116, v95, v96
    v_mfma_f32_16x16x32_bf16 v[16:19], v[2:5], v[228:231], 0
    v_max3_f32 v116, v116, v97, v98
    v_max3_f32 v116, v116, v99, v100
    v_mfma_f32_16x16x32_bf16 v[16:19], v[2:5], v[232:235], v[16:19]
    v_max3_f32 v116, v116, v101, v102
    v_max3_f32 v116, v116, v103, v104
    v_mfma_f32_16x16x32_bf16 v[16:19], v[2:5], v[236:239], v[16:19]
    v_max3_f32 v116, v116, v105, v106
    v_max3_f32 v116, v116, v107, v108
    v_mfma_f32_16x16x32_bf16 v[60:63], a[64:67], v[228:231], 0
    v_max3_f32 v116, v116, v109, v110
    v_max3_f32 v116, v116, v111, v112
    v_mfma_f32_16x16x32_bf16 v[64:67], a[76:79], v[228:231], 0
    v_max3_f32 v116, v116, v113, v114
    v_max_f32 v116, v116, v115
    v_mfma_f32_16x16x32_bf16 v[60:63], a[68:71], v[232:235], v[60:63]
    v_rcp_f32 v26, v16
    v_mfma_f32_16x16x32_bf16 v[64:67], a[80:83], v[232:235], v[64:67]
    v_mov_b32 v117, v116
    v_mfma_f32_16x16x32_bf16 v[60:63], a[72:75], v[236:239], v[60:63]
    v_mfma_f32_16x16x32_bf16 v[64:67], a[84:87], v[236:239], v[64:67]
    v_permlane16_swap_b32 v116, v117
    v_mfma_f32_16x16x32_bf16 v[68:71], a[88:91], v[228:231], 0
    v_max_f32 v116, v116, v117
    v_mov_b32 v117, v116
    v_mfma_f32_16x16x32_bf16 v[72:75], a[100:103], v[228:231], 0
    v_mfma_f32_16x16x32_bf16 v[68:71], a[92:95], v[232:235], v[68:71]
    v_permlane32_swap_b32 v116, v117
    v_mul_f32 v60, v60, v26
    v_mul_f32 v61, v61, v26
    v_mfma_f32_16x16x32_bf16 v[72:75], a[104:107], v[232:235], v[72:75]
    v_mul_f32 v62, v62, v26
    v_mul_f32 v63, v63, v26
    v_mfma_f32_16x16x32_bf16 v[68:71], a[96:99], v[236:239], v[68:71]
    v_mul_f32 v64, v64, v26
    v_mul_f32 v65, v65, v26
    v_mfma_f32_16x16x32_bf16 v[72:75], a[108:111], v[236:239], v[72:75]
    v_mul_f32 v66, v66, v26
    v_mul_f32 v67, v67, v26
    v_mfma_f32_16x16x32_bf16 v[76:79], a[112:115], v[228:231], 0
    v_cvt_pk_bf16_f32 v60, v60, v61
    v_cvt_pk_bf16_f32 v61, v62, v63
    v_mfma_f32_16x16x32_bf16 v[80:83], a[124:127], v[228:231], 0
    v_cvt_pk_bf16_f32 v62, v64, v65
    v_cvt_pk_bf16_f32 v63, v66, v67
    v_mfma_f32_16x16x32_bf16 v[76:79], a[116:119], v[232:235], v[76:79]
    buffer_store_dwordx4 v[60:63], v20, s[24:27], s59 offen offset:0 sc0 sc1
    v_mul_f32 v68, v68, v26
    v_mul_f32 v69, v69, v26
    v_mfma_f32_16x16x32_bf16 v[80:83], a[128:131], v[232:235], v[80:83]
    v_mul_f32 v70, v70, v26
    v_mul_f32 v71, v71, v26
    v_mfma_f32_16x16x32_bf16 v[76:79], a[120:123], v[236:239], v[76:79]
    v_mul_f32 v72, v72, v26
    v_mul_f32 v73, v73, v26
    v_mfma_f32_16x16x32_bf16 v[80:83], a[132:135], v[236:239], v[80:83]
    v_mul_f32 v74, v74, v26
    v_mul_f32 v75, v75, v26
    v_mfma_f32_16x16x32_bf16 v[84:87], a[136:139], v[228:231], 0
    v_cvt_pk_bf16_f32 v68, v68, v69
    v_cvt_pk_bf16_f32 v69, v70, v71
    v_mfma_f32_16x16x32_bf16 v[88:91], a[148:151], v[228:231], 0
    v_cvt_pk_bf16_f32 v70, v72, v73
    v_cvt_pk_bf16_f32 v71, v74, v75
    v_mfma_f32_16x16x32_bf16 v[84:87], a[140:143], v[232:235], v[84:87]
    buffer_store_dwordx4 v[68:71], v20, s[24:27], s59 offen offset:1024 sc0 sc1
    v_mul_f32 v76, v76, v26
    v_mul_f32 v77, v77, v26
    v_mfma_f32_16x16x32_bf16 v[88:91], a[152:155], v[232:235], v[88:91]
    v_mul_f32 v78, v78, v26
    v_mul_f32 v79, v79, v26
    v_mfma_f32_16x16x32_bf16 v[84:87], a[144:147], v[236:239], v[84:87]
    v_mul_f32 v80, v80, v26
    v_mul_f32 v81, v81, v26
    v_mfma_f32_16x16x32_bf16 v[88:91], a[156:159], v[236:239], v[88:91]
    v_mul_f32 v82, v82, v26
    v_mul_f32 v83, v83, v26
    v_cvt_pk_bf16_f32 v76, v76, v77
    v_cvt_pk_bf16_f32 v77, v78, v79
    v_cvt_pk_bf16_f32 v78, v80, v81
    v_cvt_pk_bf16_f32 v79, v82, v83
    buffer_store_dwordx4 v[76:79], v20, s[24:27], s59 offen offset:2048 sc0 sc1
    v_pk_mul_f32 v[84:85], v[84:85], v[26:27] op_sel_hi:[1,0]
    v_pk_mul_f32 v[86:87], v[86:87], v[26:27] op_sel_hi:[1,0]
    v_pk_mul_f32 v[88:89], v[88:89], v[26:27] op_sel_hi:[1,0]
    v_pk_mul_f32 v[90:91], v[90:91], v[26:27] op_sel_hi:[1,0]
    v_cvt_pk_bf16_f32 v84, v84, v85
    v_cvt_pk_bf16_f32 v85, v86, v87
    v_cvt_pk_bf16_f32 v86, v88, v89
    v_cvt_pk_bf16_f32 v87, v90, v91
    buffer_store_dwordx4 v[84:87], v20, s[24:27], s59 offen offset:3072 sc0 sc1
    v_max_f32 v116, v116, v117
    v_mul_f32 v116, s56, v116
    v_pk_fma_f32 v[92:93], v[92:93], s[44:45], v[116:117] op_sel_hi:[1,1,0] neg_lo:[0,0,1] neg_hi:[0,0,1]
    v_pk_fma_f32 v[94:95], v[94:95], s[44:45], v[116:117] op_sel_hi:[1,1,0] neg_lo:[0,0,1] neg_hi:[0,0,1]
    v_exp_f32 v92, v92
    v_exp_f32 v93, v93
    v_exp_f32 v94, v94
    v_exp_f32 v95, v95
    v_pk_fma_f32 v[96:97], v[96:97], s[44:45], v[116:117] op_sel_hi:[1,1,0] neg_lo:[0,0,1] neg_hi:[0,0,1]
    v_pk_fma_f32 v[98:99], v[98:99], s[44:45], v[116:117] op_sel_hi:[1,1,0] neg_lo:[0,0,1] neg_hi:[0,0,1]
    v_cvt_pk_bf16_f32 v244, v92, v93
    v_cvt_pk_bf16_f32 v245, v94, v95
    v_exp_f32 v96, v96
    v_exp_f32 v97, v97
    v_exp_f32 v98, v98
    v_exp_f32 v99, v99
    v_pk_fma_f32 v[100:101], v[100:101], s[44:45], v[116:117] op_sel_hi:[1,1,0] neg_lo:[0,0,1] neg_hi:[0,0,1]
    v_pk_fma_f32 v[102:103], v[102:103], s[44:45], v[116:117] op_sel_hi:[1,1,0] neg_lo:[0,0,1] neg_hi:[0,0,1]
    v_cvt_pk_bf16_f32 v246, v96, v97
    v_cvt_pk_bf16_f32 v247, v98, v99
    v_exp_f32 v100, v100
    v_exp_f32 v101, v101
    v_exp_f32 v102, v102
    v_exp_f32 v103, v103
    v_pk_fma_f32 v[104:105], v[104:105], s[44:45], v[116:117] op_sel_hi:[1,1,0] neg_lo:[0,0,1] neg_hi:[0,0,1]
    v_pk_fma_f32 v[106:107], v[106:107], s[44:45], v[116:117] op_sel_hi:[1,1,0] neg_lo:[0,0,1] neg_hi:[0,0,1]
    v_cvt_pk_bf16_f32 v248, v100, v101
    v_cvt_pk_bf16_f32 v249, v102, v103
    v_exp_f32 v104, v104
    v_exp_f32 v105, v105
    v_exp_f32 v106, v106
    v_exp_f32 v107, v107
    v_pk_fma_f32 v[108:109], v[108:109], s[44:45], v[116:117] op_sel_hi:[1,1,0] neg_lo:[0,0,1] neg_hi:[0,0,1]
    v_pk_fma_f32 v[110:111], v[110:111], s[44:45], v[116:117] op_sel_hi:[1,1,0] neg_lo:[0,0,1] neg_hi:[0,0,1]
    v_cvt_pk_bf16_f32 v250, v104, v105
    v_cvt_pk_bf16_f32 v251, v106, v107
    v_exp_f32 v108, v108
    v_exp_f32 v109, v109
    v_exp_f32 v110, v110
    v_exp_f32 v111, v111
    v_pk_fma_f32 v[112:113], v[112:113], s[44:45], v[116:117] op_sel_hi:[1,1,0] neg_lo:[0,0,1] neg_hi:[0,0,1]
    v_pk_fma_f32 v[114:115], v[114:115], s[44:45], v[116:117] op_sel_hi:[1,1,0] neg_lo:[0,0,1] neg_hi:[0,0,1]
    v_cvt_pk_bf16_f32 v252, v108, v109
    v_cvt_pk_bf16_f32 v253, v110, v111
    v_exp_f32 v112, v112
    v_exp_f32 v113, v113
    v_exp_f32 v114, v114
    v_exp_f32 v115, v115
    v_cvt_pk_bf16_f32 v254, v112, v113
    v_cvt_pk_bf16_f32 v255, v114, v115
    s_nop 1
    v_mfma_f32_16x16x32_bf16 v[16:19], v[2:5], v[244:247], 0
    v_mfma_f32_16x16x32_bf16 v[16:19], v[2:5], v[248:251], v[16:19]
    v_mfma_f32_16x16x32_bf16 v[16:19], v[2:5], v[252:255], v[16:19]
    v_mfma_f32_16x16x32_bf16 v[92:95], a[64:67], v[244:247], 0
    v_mfma_f32_16x16x32_bf16 v[96:99], a[76:79], v[244:247], 0
    v_mfma_f32_16x16x32_bf16 v[92:95], a[68:71], v[248:251], v[92:95]
    v_mfma_f32_16x16x32_bf16 v[96:99], a[80:83], v[248:251], v[96:99]
    v_mfma_f32_16x16x32_bf16 v[92:95], a[72:75], v[252:255], v[92:95]
    v_mfma_f32_16x16x32_bf16 v[96:99], a[84:87], v[252:255], v[96:99]
    v_mfma_f32_16x16x32_bf16 v[100:103], a[88:91], v[244:247], 0
    v_mfma_f32_16x16x32_bf16 v[104:107], a[100:103], v[244:247], 0
    v_rcp_f32 v27, v16
    v_mfma_f32_16x16x32_bf16 v[100:103], a[92:95], v[248:251], v[100:103]
    v_mfma_f32_16x16x32_bf16 v[104:107], a[104:107], v[248:251], v[104:107]
    v_mfma_f32_16x16x32_bf16 v[100:103], a[96:99], v[252:255], v[100:103]
    v_mfma_f32_16x16x32_bf16 v[104:107], a[108:111], v[252:255], v[104:107]
    v_mul_f32 v92, v92, v27
    v_mul_f32 v93, v93, v27
    v_mfma_f32_16x16x32_bf16 v[108:111], a[112:115], v[244:247], 0
    v_mul_f32 v94, v94, v27
    v_mul_f32 v95, v95, v27
    v_mfma_f32_16x16x32_bf16 v[112:115], a[124:127], v[244:247], 0
    v_mul_f32 v96, v96, v27
    v_mul_f32 v97, v97, v27
    v_mfma_f32_16x16x32_bf16 v[108:111], a[116:119], v[248:251], v[108:111]
    v_mul_f32 v98, v98, v27
    v_mul_f32 v99, v99, v27
    v_mfma_f32_16x16x32_bf16 v[112:115], a[128:131], v[248:251], v[112:115]
    v_cvt_pk_bf16_f32 v92, v92, v93
    v_cvt_pk_bf16_f32 v93, v94, v95
    v_mfma_f32_16x16x32_bf16 v[108:111], a[120:123], v[252:255], v[108:111]
    v_cvt_pk_bf16_f32 v94, v96, v97
    v_cvt_pk_bf16_f32 v95, v98, v99
    v_mfma_f32_16x16x32_bf16 v[112:115], a[132:135], v[252:255], v[112:115]
    buffer_store_dwordx4 v[92:95], v20, s[24:27], s57 offen offset:0 sc0 sc1
    v_mul_f32 v100, v100, v27
    v_mul_f32 v101, v101, v27
    v_mfma_f32_16x16x32_bf16 v[116:119], a[136:139], v[244:247], 0
    v_mul_f32 v102, v102, v27
    v_mul_f32 v103, v103, v27
    v_mfma_f32_16x16x32_bf16 v[120:123], a[148:151], v[244:247], 0
    v_mul_f32 v104, v104, v27
    v_mul_f32 v105, v105, v27
    v_mfma_f32_16x16x32_bf16 v[116:119], a[140:143], v[248:251], v[116:119]
    v_mul_f32 v106, v106, v27
    v_mul_f32 v107, v107, v27
    v_mfma_f32_16x16x32_bf16 v[120:123], a[152:155], v[248:251], v[120:123]
    v_cvt_pk_bf16_f32 v100, v100, v101
    v_cvt_pk_bf16_f32 v101, v102, v103
    v_mfma_f32_16x16x32_bf16 v[116:119], a[144:147], v[252:255], v[116:119]
    v_cvt_pk_bf16_f32 v102, v104, v105
    v_cvt_pk_bf16_f32 v103, v106, v107
    v_mfma_f32_16x16x32_bf16 v[120:123], a[156:159], v[252:255], v[120:123]
    buffer_store_dwordx4 v[100:103], v20, s[24:27], s57 offen offset:1024 sc0 sc1
    v_mul_f32 v108, v108, v27
    v_mul_f32 v109, v109, v27
    v_pk_mul_f32 v[110:111], v[110:111], v[26:27] op_sel:[0,1] op_sel_hi:[1,1]
    v_pk_mul_f32 v[112:113], v[112:113], v[26:27] op_sel:[0,1] op_sel_hi:[1,1]
    v_pk_mul_f32 v[114:115], v[114:115], v[26:27] op_sel:[0,1] op_sel_hi:[1,1]
    v_cvt_pk_bf16_f32 v108, v108, v109
    v_cvt_pk_bf16_f32 v109, v110, v111
    v_cvt_pk_bf16_f32 v110, v112, v113
    v_cvt_pk_bf16_f32 v111, v114, v115
    buffer_store_dwordx4 v[108:111], v20, s[24:27], s57 offen offset:2048 sc0 sc1
    v_pk_mul_f32 v[116:117], v[116:117], v[26:27] op_sel:[0,1] op_sel_hi:[1,1]
    v_pk_mul_f32 v[118:119], v[118:119], v[26:27] op_sel:[0,1] op_sel_hi:[1,1]
    v_pk_mul_f32 v[120:121], v[120:121], v[26:27] op_sel:[0,1] op_sel_hi:[1,1]
    v_pk_mul_f32 v[122:123], v[122:123], v[26:27] op_sel:[0,1] op_sel_hi:[1,1]
    v_cvt_pk_bf16_f32 v116, v116, v117
    v_cvt_pk_bf16_f32 v117, v118, v119
    v_cvt_pk_bf16_f32 v118, v120, v121
    v_cvt_pk_bf16_f32 v119, v122, v123
    buffer_store_dwordx4 v[116:119], v20, s[24:27], s57 offen offset:3072 sc0 sc1
    s_add_u32 m0, s67, 32768
    s_add_u32 s68, s64, 2
    s_and_b32 s68, s68, 15
    s_mul_i32 s68, s68, 40960
    s_add_u32 s68, s68, s66
    buffer_load_dwordx4 v208, s[28:31], s68 offen offset:0  lds
    buffer_load_dwordx4 v209, s[28:31], s68 offen offset:1024  lds
    buffer_load_dwordx4 v210, s[28:31], s68 offen offset:2048  lds
    buffer_load_dwordx4 v211, s[28:31], s68 offen offset:3072  lds
    s_add_u32 m0, s67, 49152
    s_add_u32 s68, s64, 3
    s_and_b32 s68, s68, 15
    s_mul_i32 s68, s68, 40960
    s_add_u32 s68, s68, s66
    buffer_load_dwordx4 v208, s[28:31], s68 offen offset:0  lds
    buffer_load_dwordx4 v209, s[28:31], s68 offen offset:1024  lds
    buffer_load_dwordx4 v210, s[28:31], s68 offen offset:2048  lds
    buffer_load_dwordx4 v211, s[28:31], s68 offen offset:3072  lds

    v_lshrrev_b32 v24, 3, v0
    v_mul_u32_u24 v24, 1280, v24
    v_and_b32 v25, 7, v0
    v_lshrrev_b32 v26, 4, v0
    v_lshlrev_b32 v26, 1, v26
    v_xor_b32 v25, v25, v26
    v_lshl_add_u32 v24, v25, 4, v24
    v_add_u32 v2, s61, v24

    v_add_u32 v3, 9216, v2
    v_add_u32 v4, 18432, v2
    v_add_u32 v5, 27648, v2

    v_lshrrev_b32 v24, 2, v0
    v_lshlrev_b32 v24, 7, v24
    v_bfe_u32 v25, v0, 3, 2
    v_lshl_add_u32 v24, v25, 5, v24
    v_and_b32 v25, 3, v0
    v_lshl_add_u32 v24, v25, 3, v24
    s_add_u32 s3, s67, 0
    v_add_u32 v10, s3, v24

    v_xor_b32 v11, 32, v10
    v_xor_b32 v12, 64, v10
    v_xor_b32 v13, 96, v10
    v_add_u32 v14, 65536, v10
    v_add_u32 v15, 65536, v11
    v_add_u32 v16, 65536, v12
    v_add_u32 v17, 65536, v13
    v_add_u32 v18, 131072, v10
    v_add_u32 v19, 131072, v11
    v_add_u32 v20, 131072, v12
    v_add_u32 v21, 131072, v13

    s_lshl_b32 s3, s5, 2
    s_add_u32 s3, s3, s7
    s_lshl_b32 s3, s3, 5
    s_add_u32 s3, s3, s6
    s_lshl_b32 s3, s3, 2
    s_add_u32 s3, s3, s4
    s_lshl_b32 s56, s3, 7
    s_add_u32 s56, s56, 67108864
    v_lshlrev_b32 v27, 3, v0
    v_mov_b32 v24, 0
    s_mov_b32 s57, 0

    s_waitcnt vmcnt(8)

P2_tok:
    v_readfirstlane_b32 s3, v22
    s_cmp_lg_u32 s3, 0
    s_cbranch_scc1 P2_tokok
    buffer_load_dwordx2 v[22:23], v24, s[32:35], 0 offen sc1
    s_add_u32 s57, s57, 1
    s_waitcnt vmcnt(0)
    s_cmp_lt_u32 s57, 100000
    s_cbranch_scc1 P2_tok
P2_tokok:
    s_mov_b64 exec, 65535
    buffer_store_dwordx2 v[22:23], v27, s[24:27], s56 offen sc0 sc1
    s_mov_b64 exec, -1

    s_cmp_ge_u32 s2, 240
    s_cbranch_scc1 P2_done

    s_add_u32 m0, s67, 65536
    s_add_u32 s68, s64, 4
    s_and_b32 s68, s68, 15
    s_mul_i32 s68, s68, 40960
    s_add_u32 s68, s68, s66
    buffer_load_dwordx4 v2, s[28:31], s68 offen offset:0  lds
    buffer_load_dwordx4 v3, s[28:31], s68 offen offset:1024  lds
    buffer_load_dwordx4 v4, s[28:31], s68 offen offset:2048  lds
    buffer_load_dwordx4 v5, s[28:31], s68 offen offset:3072  lds
    s_add_u32 m0, s67, 81920
    s_add_u32 s68, s64, 5
    s_and_b32 s68, s68, 15
    s_mul_i32 s68, s68, 40960
    s_add_u32 s68, s68, s66
    buffer_load_dwordx4 v2, s[28:31], s68 offen offset:0  lds
    buffer_load_dwordx4 v3, s[28:31], s68 offen offset:1024  lds
    buffer_load_dwordx4 v4, s[28:31], s68 offen offset:2048  lds
    buffer_load_dwordx4 v5, s[28:31], s68 offen offset:3072  lds
    s_add_u32 m0, s67, 98304
    s_add_u32 s68, s64, 6
    s_and_b32 s68, s68, 15
    s_mul_i32 s68, s68, 40960
    s_add_u32 s68, s68, s66
    buffer_load_dwordx4 v2, s[28:31], s68 offen offset:0  lds
    buffer_load_dwordx4 v3, s[28:31], s68 offen offset:1024  lds
    buffer_load_dwordx4 v4, s[28:31], s68 offen offset:2048  lds
    buffer_load_dwordx4 v5, s[28:31], s68 offen offset:3072  lds
    s_barrier
    s_add_u32 m0, s67, 114688
    s_add_u32 s68, s64, 7
    s_and_b32 s68, s68, 15
    s_mul_i32 s68, s68, 40960
    s_add_u32 s68, s68, s66
    buffer_load_dwordx4 v2, s[28:31], s68 offen offset:0  lds
    buffer_load_dwordx4 v3, s[28:31], s68 offen offset:1024  lds
    buffer_load_dwordx4 v4, s[28:31], s68 offen offset:2048  lds
    buffer_load_dwordx4 v5, s[28:31], s68 offen offset:3072  lds
    s_add_u32 m0, s67, 131072
    s_add_u32 s68, s64, 8
    s_and_b32 s68, s68, 15
    s_mul_i32 s68, s68, 40960
    s_add_u32 s68, s68, s66
    buffer_load_dwordx4 v2, s[28:31], s68 offen offset:0  lds
    buffer_load_dwordx4 v3, s[28:31], s68 offen offset:1024  lds
    buffer_load_dwordx4 v4, s[28:31], s68 offen offset:2048  lds
    buffer_load_dwordx4 v5, s[28:31], s68 offen offset:3072  lds
    s_add_u32 m0, s67, 147456
    s_add_u32 s68, s64, 9
    s_and_b32 s68, s68, 15
    s_mul_i32 s68, s68, 40960
    s_add_u32 s68, s68, s66
    buffer_load_dwordx4 v2, s[28:31], s68 offen offset:0  lds
    buffer_load_dwordx4 v3, s[28:31], s68 offen offset:1024  lds
    buffer_load_dwordx4 v4, s[28:31], s68 offen offset:2048  lds
    buffer_load_dwordx4 v5, s[28:31], s68 offen offset:3072  lds
    ds_read_b64_tr_b16 a[0:1], v10 offset:0
    ds_read_b64_tr_b16 a[2:3], v10 offset:2048
    ds_read_b64_tr_b16 a[4:5], v11 offset:0
    ds_read_b64_tr_b16 a[6:7], v11 offset:2048
    ds_read_b64_tr_b16 a[8:9], v12 offset:0
    ds_read_b64_tr_b16 a[10:11], v12 offset:2048
    ds_read_b64_tr_b16 a[12:13], v13 offset:0
    ds_read_b64_tr_b16 a[14:15], v13 offset:2048
    ds_read_b64_tr_b16 a[16:17], v10 offset:16384
    ds_read_b64_tr_b16 a[18:19], v10 offset:18432
    ds_read_b64_tr_b16 a[20:21], v11 offset:16384
    ds_read_b64_tr_b16 a[22:23], v11 offset:18432
    ds_read_b64_tr_b16 a[24:25], v12 offset:16384
    ds_read_b64_tr_b16 a[26:27], v12 offset:18432
    ds_read_b64_tr_b16 a[28:29], v13 offset:16384
    ds_read_b64_tr_b16 a[30:31], v13 offset:18432
    s_waitcnt lgkmcnt(8)
    s_add_u32 m0, s67, 0
    s_add_u32 s68, s64, 10
    s_and_b32 s68, s68, 15
    s_mul_i32 s68, s68, 40960
    s_add_u32 s68, s68, s66
    buffer_load_dwordx4 v2, s[28:31], s68 offen offset:0  lds
    buffer_load_dwordx4 v3, s[28:31], s68 offen offset:1024  lds
    buffer_load_dwordx4 v4, s[28:31], s68 offen offset:2048  lds
    buffer_load_dwordx4 v5, s[28:31], s68 offen offset:3072  lds
    s_waitcnt vmcnt(33)
    ds_read_b64_tr_b16 a[32:33], v10 offset:32768
    ds_read_b64_tr_b16 a[34:35], v10 offset:34816
    ds_read_b64_tr_b16 a[36:37], v11 offset:32768
    ds_read_b64_tr_b16 a[38:39], v11 offset:34816
    ds_read_b64_tr_b16 a[40:41], v12 offset:32768
    ds_read_b64_tr_b16 a[42:43], v12 offset:34816
    ds_read_b64_tr_b16 a[44:45], v13 offset:32768
    ds_read_b64_tr_b16 a[46:47], v13 offset:34816
    s_waitcnt lgkmcnt(8)
    s_add_u32 m0, s67, 16384
    s_add_u32 s68, s64, 11
    s_and_b32 s68, s68, 15
    s_mul_i32 s68, s68, 40960
    s_add_u32 s68, s68, s66
    buffer_load_dwordx4 v2, s[28:31], s68 offen offset:0  lds
    buffer_load_dwordx4 v3, s[28:31], s68 offen offset:1024  lds
    buffer_load_dwordx4 v4, s[28:31], s68 offen offset:2048  lds
    buffer_load_dwordx4 v5, s[28:31], s68 offen offset:3072  lds
    s_waitcnt vmcnt(33)
    ds_read_b64_tr_b16 a[48:49], v10 offset:49152
    ds_read_b64_tr_b16 a[50:51], v10 offset:51200
    ds_read_b64_tr_b16 a[52:53], v11 offset:49152
    ds_read_b64_tr_b16 a[54:55], v11 offset:51200
    ds_read_b64_tr_b16 a[56:57], v12 offset:49152
    ds_read_b64_tr_b16 a[58:59], v12 offset:51200
    ds_read_b64_tr_b16 a[60:61], v13 offset:49152
    ds_read_b64_tr_b16 a[62:63], v13 offset:51200
    s_waitcnt lgkmcnt(8)
    s_add_u32 m0, s67, 32768
    s_add_u32 s68, s64, 12
    s_and_b32 s68, s68, 15
    s_mul_i32 s68, s68, 40960
    s_add_u32 s68, s68, s66
    buffer_load_dwordx4 v2, s[28:31], s68 offen offset:0  lds
    buffer_load_dwordx4 v3, s[28:31], s68 offen offset:1024  lds
    buffer_load_dwordx4 v4, s[28:31], s68 offen offset:2048  lds
    buffer_load_dwordx4 v5, s[28:31], s68 offen offset:3072  lds
    s_waitcnt vmcnt(32)
    ds_read_b64_tr_b16 a[64:65], v14 offset:0
    ds_read_b64_tr_b16 a[66:67], v14 offset:2048
    ds_read_b64_tr_b16 a[68:69], v15 offset:0
    ds_read_b64_tr_b16 a[70:71], v15 offset:2048
    ds_read_b64_tr_b16 a[72:73], v16 offset:0
    ds_read_b64_tr_b16 a[74:75], v16 offset:2048
    ds_read_b64_tr_b16 a[76:77], v17 offset:0
    ds_read_b64_tr_b16 a[78:79], v17 offset:2048
    s_waitcnt lgkmcnt(8)
    s_add_u32 m0, s67, 49152
    s_add_u32 s68, s64, 13
    s_and_b32 s68, s68, 15
    s_mul_i32 s68, s68, 40960
    s_add_u32 s68, s68, s66
    buffer_load_dwordx4 v2, s[28:31], s68 offen offset:0  lds
    buffer_load_dwordx4 v3, s[28:31], s68 offen offset:1024  lds
    buffer_load_dwordx4 v4, s[28:31], s68 offen offset:2048  lds
    buffer_load_dwordx4 v5, s[28:31], s68 offen offset:3072  lds
    s_waitcnt vmcnt(32)
    ds_read_b64_tr_b16 a[80:81], v14 offset:16384
    ds_read_b64_tr_b16 a[82:83], v14 offset:18432
    ds_read_b64_tr_b16 a[84:85], v15 offset:16384
    ds_read_b64_tr_b16 a[86:87], v15 offset:18432
    ds_read_b64_tr_b16 a[88:89], v16 offset:16384
    ds_read_b64_tr_b16 a[90:91], v16 offset:18432
    ds_read_b64_tr_b16 a[92:93], v17 offset:16384
    ds_read_b64_tr_b16 a[94:95], v17 offset:18432
    s_waitcnt lgkmcnt(8)
    s_add_u32 m0, s67, 65536
    s_add_u32 s68, s64, 14
    s_and_b32 s68, s68, 15
    s_mul_i32 s68, s68, 40960
    s_add_u32 s68, s68, s66
    buffer_load_dwordx4 v2, s[28:31], s68 offen offset:0  lds
    buffer_load_dwordx4 v3, s[28:31], s68 offen offset:1024  lds
    buffer_load_dwordx4 v4, s[28:31], s68 offen offset:2048  lds
    buffer_load_dwordx4 v5, s[28:31], s68 offen offset:3072  lds
    s_waitcnt lgkmcnt(0)
    s_add_u32 m0, s67, 81920
    s_add_u32 s68, s64, 15
    s_and_b32 s68, s68, 15
    s_mul_i32 s68, s68, 40960
    s_add_u32 s68, s68, s66
    buffer_load_dwordx4 v2, s[28:31], s68 offen offset:0  lds
    buffer_load_dwordx4 v3, s[28:31], s68 offen offset:1024  lds
    buffer_load_dwordx4 v4, s[28:31], s68 offen offset:2048  lds
    buffer_load_dwordx4 v5, s[28:31], s68 offen offset:3072  lds
    v_lshlrev_b32 v1, 4, v0
    s_add_u32 s3, s4, 0
    s_and_b32 s3, s3, 3
    s_lshl_b32 s3, s3, 17
    v_add_u32 v6, s3, v1
    s_add_u32 s3, s4, 1
    s_and_b32 s3, s3, 3
    s_lshl_b32 s3, s3, 17
    v_add_u32 v7, s3, v1
    s_add_u32 s3, s4, 2
    s_and_b32 s3, s3, 3
    s_lshl_b32 s3, s3, 17
    v_add_u32 v8, s3, v1
    s_add_u32 s3, s4, 3
    s_and_b32 s3, s3, 3
    s_lshl_b32 s3, s3, 17
    v_add_u32 v9, s3, v1

    s_lshl_b32 s70, s62, 1
    s_add_u32 s70, s70, s60
    s_xor_b32 s71, s70, 1
    s_mul_i32 s3, s5, 12
    s_add_u32 s72, s3, s71
    s_add_u32 s73, s3, s70
    s_lshl_b32 s72, s72, 19
    s_lshl_b32 s73, s73, 19
    s_lshl_b32 s3, s65, 14
    s_add_u32 s72, s72, s3
    s_add_u32 s73, s73, s3
    s_mul_i32 s56, s71, 43
    s_lshr_b32 s56, s56, 7
    s_mul_i32 s57, s70, 43
    s_lshr_b32 s57, s57, 7
    s_lshl_b32 s56, s56, 14
    s_lshl_b32 s57, s57, 14
    v_mov_b32 v25, s56
    v_mov_b32 v26, s57
    v_and_b32 v156, 16, v0
    v_cmp_eq_u32 vcc, 0, v156
    v_and_b32 v156, 15, v0
    v_lshlrev_b32 v156, 7, v156
    v_cndmask_b32 v25, v26, v25, vcc
    v_add_u32 v25, v156, v25
    s_lshl_b32 s56, s5, 16
    s_lshl_b32 s3, s65, 11
    s_add_u32 s56, s56, s3
    s_add_u32 s56, s56, 67108864
    s_mov_b32 s57, 0
    s_lshl_b32 s3, s2, 2
    s_add_u32 s3, s3, s4
    s_lshl_b32 s58, s3, 12
    s_add_u32 s58, s58, 83886080
    s_lshl_b32 s59, s3, 7
    s_add_u32 s59, s59, 68157440
    s_xor_b32 s3, s3, 8
    s_lshl_b32 s74, s3, 12
    s_add_u32 s74, s74, 83886080
    s_lshl_b32 s69, s3, 7
    s_add_u32 s69, s69, 68157440
    v_add_u32 v252, s67, v1

    s_sub_u32 s3, s4, 1
    s_and_b32 s3, s3, 3
    s_lshl_b32 s3, s3, 12
    v_add_u32 v253, s3, v1
    s_sub_u32 s3, s4, 2
    s_and_b32 s3, s3, 3
    s_lshl_b32 s3, s3, 12
    v_add_u32 v254, s3, v1
    s_sub_u32 s3, s4, 3
    s_and_b32 s3, s3, 3
    s_lshl_b32 s3, s3, 12
    v_add_u32 v255, s3, v1
    buffer_load_dwordx2 v[26:27], v25, s[24:27], s56 offen sc1
    s_waitcnt vmcnt(37)
    ds_read_b64_tr_b16 a[96:97], v14 offset:32768
    ds_read_b64_tr_b16 a[98:99], v14 offset:34816
    ds_read_b64_tr_b16 a[100:101], v15 offset:32768
    ds_read_b64_tr_b16 a[102:103], v15 offset:34816
    ds_read_b64_tr_b16 a[104:105], v16 offset:32768
    ds_read_b64_tr_b16 a[106:107], v16 offset:34816
    ds_read_b64_tr_b16 a[108:109], v17 offset:32768
    ds_read_b64_tr_b16 a[110:111], v17 offset:34816
    s_waitcnt vmcnt(33)
    ds_read_b64_tr_b16 a[112:113], v14 offset:49152
    ds_read_b64_tr_b16 a[114:115], v14 offset:51200
    ds_read_b64_tr_b16 a[116:117], v15 offset:49152
    ds_read_b64_tr_b16 a[118:119], v15 offset:51200
    ds_read_b64_tr_b16 a[120:121], v16 offset:49152
    ds_read_b64_tr_b16 a[122:123], v16 offset:51200
    ds_read_b64_tr_b16 a[124:125], v17 offset:49152
    ds_read_b64_tr_b16 a[126:127], v17 offset:51200
    s_waitcnt vmcnt(29)
    ds_read_b64_tr_b16 a[128:129], v18 offset:0
    ds_read_b64_tr_b16 a[130:131], v18 offset:2048
    ds_read_b64_tr_b16 a[132:133], v19 offset:0
    ds_read_b64_tr_b16 a[134:135], v19 offset:2048
    ds_read_b64_tr_b16 a[136:137], v20 offset:0
    ds_read_b64_tr_b16 a[138:139], v20 offset:2048
    ds_read_b64_tr_b16 a[140:141], v21 offset:0
    ds_read_b64_tr_b16 a[142:143], v21 offset:2048
    s_waitcnt vmcnt(25)
    ds_read_b64_tr_b16 a[144:145], v18 offset:16384
    ds_read_b64_tr_b16 a[146:147], v18 offset:18432
    ds_read_b64_tr_b16 a[148:149], v19 offset:16384
    ds_read_b64_tr_b16 a[150:151], v19 offset:18432
    ds_read_b64_tr_b16 a[152:153], v20 offset:16384
    ds_read_b64_tr_b16 a[154:155], v20 offset:18432
    ds_read_b64_tr_b16 a[156:157], v21 offset:16384
    ds_read_b64_tr_b16 a[158:159], v21 offset:18432
    s_waitcnt vmcnt(21)
    ds_read_b64_tr_b16 a[160:161], v10 offset:0
    ds_read_b64_tr_b16 a[162:163], v10 offset:2048
    ds_read_b64_tr_b16 a[164:165], v11 offset:0
    ds_read_b64_tr_b16 a[166:167], v11 offset:2048
    ds_read_b64_tr_b16 a[168:169], v12 offset:0
    ds_read_b64_tr_b16 a[170:171], v12 offset:2048
    ds_read_b64_tr_b16 a[172:173], v13 offset:0
    ds_read_b64_tr_b16 a[174:175], v13 offset:2048
    s_waitcnt vmcnt(17)
    ds_read_b64_tr_b16 a[176:177], v10 offset:16384
    ds_read_b64_tr_b16 a[178:179], v10 offset:18432
    ds_read_b64_tr_b16 a[180:181], v11 offset:16384
    ds_read_b64_tr_b16 a[182:183], v11 offset:18432
    ds_read_b64_tr_b16 a[184:185], v12 offset:16384
    ds_read_b64_tr_b16 a[186:187], v12 offset:18432
    ds_read_b64_tr_b16 a[188:189], v13 offset:16384
    ds_read_b64_tr_b16 a[190:191], v13 offset:18432
    s_waitcnt vmcnt(13)
    ds_read_b64_tr_b16 a[192:193], v10 offset:32768
    ds_read_b64_tr_b16 a[194:195], v10 offset:34816
    ds_read_b64_tr_b16 a[196:197], v11 offset:32768
    ds_read_b64_tr_b16 a[198:199], v11 offset:34816
    ds_read_b64_tr_b16 a[200:201], v12 offset:32768
    ds_read_b64_tr_b16 a[202:203], v12 offset:34816
    ds_read_b64_tr_b16 a[204:205], v13 offset:32768
    ds_read_b64_tr_b16 a[206:207], v13 offset:34816
    s_waitcnt vmcnt(9)
    ds_read_b64_tr_b16 a[208:209], v10 offset:49152
    ds_read_b64_tr_b16 a[210:211], v10 offset:51200
    ds_read_b64_tr_b16 a[212:213], v11 offset:49152
    ds_read_b64_tr_b16 a[214:215], v11 offset:51200
    ds_read_b64_tr_b16 a[216:217], v12 offset:49152
    ds_read_b64_tr_b16 a[218:219], v12 offset:51200
    ds_read_b64_tr_b16 a[220:221], v13 offset:49152
    ds_read_b64_tr_b16 a[222:223], v13 offset:51200
    s_waitcnt vmcnt(5)
    ds_read_b64_tr_b16 a[224:225], v14 offset:0
    ds_read_b64_tr_b16 a[226:227], v14 offset:2048
    ds_read_b64_tr_b16 a[228:229], v15 offset:0
    ds_read_b64_tr_b16 a[230:231], v15 offset:2048
    ds_read_b64_tr_b16 a[232:233], v16 offset:0
    ds_read_b64_tr_b16 a[234:235], v16 offset:2048
    ds_read_b64_tr_b16 a[236:237], v17 offset:0
    ds_read_b64_tr_b16 a[238:239], v17 offset:2048
    s_waitcnt vmcnt(1)
    ds_read_b64_tr_b16 a[240:241], v14 offset:16384
    ds_read_b64_tr_b16 a[242:243], v14 offset:18432
    ds_read_b64_tr_b16 a[244:245], v15 offset:16384
    ds_read_b64_tr_b16 a[246:247], v15 offset:18432
    ds_read_b64_tr_b16 a[248:249], v16 offset:16384
    ds_read_b64_tr_b16 a[250:251], v16 offset:18432
    ds_read_b64_tr_b16 a[252:253], v17 offset:16384
    ds_read_b64_tr_b16 a[254:255], v17 offset:18432

    s_waitcnt vmcnt(0)
    v_cmp_ne_u64 vcc, v[26:27], v[22:23]
    s_nop 4
    s_cbranch_vccz P2_go

P2_poll:
    buffer_load_dwordx2 v[26:27], v25, s[24:27], s56 offen sc1
    s_add_u32 s57, s57, 1
    s_waitcnt vmcnt(0)
    v_cmp_ne_u64 vcc, v[26:27], v[22:23]
    s_cmp_gt_u32 s57, 200000
    s_cbranch_scc1 P2_go
    s_nop 0
    s_nop 3
    s_cbranch_vccz P2_go
    s_sleep 4
    s_branch P2_poll
P2_go:

    s_add_u32 s75, s64, 0
    s_and_b32 s75, s75, 15
    s_lshl_b32 s75, s75, 10
    s_add_u32 s75, s75, s72
    buffer_load_dwordx4 v[156:159], v6, s[24:27], s75 offen sc1
    buffer_load_dwordx4 v[160:163], v7, s[24:27], s75 offen sc1
    buffer_load_dwordx4 v[164:167], v8, s[24:27], s75 offen sc1
    buffer_load_dwordx4 v[168:171], v9, s[24:27], s75 offen sc1
    s_add_u32 s75, s64, 1
    s_and_b32 s75, s75, 15
    s_lshl_b32 s75, s75, 10
    s_add_u32 s75, s75, s72
    buffer_load_dwordx4 v[172:175], v6, s[24:27], s75 offen sc1
    buffer_load_dwordx4 v[176:179], v7, s[24:27], s75 offen sc1
    buffer_load_dwordx4 v[180:183], v8, s[24:27], s75 offen sc1
    buffer_load_dwordx4 v[184:187], v9, s[24:27], s75 offen sc1
    s_add_u32 s75, s64, 2
    s_and_b32 s75, s75, 15
    s_lshl_b32 s75, s75, 10
    s_add_u32 s75, s75, s72
    buffer_load_dwordx4 v[188:191], v6, s[24:27], s75 offen sc1
    buffer_load_dwordx4 v[192:195], v7, s[24:27], s75 offen sc1
    buffer_load_dwordx4 v[196:199], v8, s[24:27], s75 offen sc1
    buffer_load_dwordx4 v[200:203], v9, s[24:27], s75 offen sc1
    s_waitcnt vmcnt(8)
    v_mfma_f32_16x16x32_bf16 v[28:31], a[0:3], v[156:159], 0
    v_mfma_f32_16x16x32_bf16 v[32:35], a[4:7], v[156:159], 0
    s_add_u32 s75, s64, 3
    s_and_b32 s75, s75, 15
    s_lshl_b32 s75, s75, 10
    s_add_u32 s75, s75, s72
    buffer_load_dwordx4 v[204:207], v6, s[24:27], s75 offen sc1
    v_mfma_f32_16x16x32_bf16 v[36:39], a[8:11], v[156:159], 0
    v_mfma_f32_16x16x32_bf16 v[40:43], a[12:15], v[156:159], 0
    buffer_load_dwordx4 v[208:211], v7, s[24:27], s75 offen sc1
    v_mfma_f32_16x16x32_bf16 v[44:47], a[0:3], v[160:163], 0
    v_mfma_f32_16x16x32_bf16 v[48:51], a[4:7], v[160:163], 0
    buffer_load_dwordx4 v[212:215], v8, s[24:27], s75 offen sc1
    v_mfma_f32_16x16x32_bf16 v[52:55], a[8:11], v[160:163], 0
    v_mfma_f32_16x16x32_bf16 v[56:59], a[12:15], v[160:163], 0
    buffer_load_dwordx4 v[216:219], v9, s[24:27], s75 offen sc1
    v_mfma_f32_16x16x32_bf16 v[60:63], a[0:3], v[164:167], 0
    v_mfma_f32_16x16x32_bf16 v[64:67], a[4:7], v[164:167], 0
    s_add_u32 s75, s64, 4
    s_and_b32 s75, s75, 15
    s_lshl_b32 s75, s75, 10
    s_add_u32 s75, s75, s72
    buffer_load_dwordx4 v[220:223], v6, s[24:27], s75 offen sc1
    v_mfma_f32_16x16x32_bf16 v[68:71], a[8:11], v[164:167], 0
    v_mfma_f32_16x16x32_bf16 v[72:75], a[12:15], v[164:167], 0
    buffer_load_dwordx4 v[224:227], v7, s[24:27], s75 offen sc1
    v_mfma_f32_16x16x32_bf16 v[76:79], a[0:3], v[168:171], 0
    v_mfma_f32_16x16x32_bf16 v[80:83], a[4:7], v[168:171], 0
    buffer_load_dwordx4 v[228:231], v8, s[24:27], s75 offen sc1
    v_mfma_f32_16x16x32_bf16 v[84:87], a[8:11], v[168:171], 0
    v_mfma_f32_16x16x32_bf16 v[88:91], a[12:15], v[168:171], 0
    buffer_load_dwordx4 v[232:235], v9, s[24:27], s75 offen sc1
    s_waitcnt vmcnt(12)
    v_mfma_f32_16x16x32_bf16 v[28:31], a[16:19], v[172:175], v[28:31]
    v_mfma_f32_16x16x32_bf16 v[32:35], a[20:23], v[172:175], v[32:35]
    s_add_u32 s75, s64, 5
    s_and_b32 s75, s75, 15
    s_lshl_b32 s75, s75, 10
    s_add_u32 s75, s75, s72
    buffer_load_dwordx4 v[236:239], v6, s[24:27], s75 offen sc1
    v_mfma_f32_16x16x32_bf16 v[36:39], a[24:27], v[172:175], v[36:39]
    v_mfma_f32_16x16x32_bf16 v[40:43], a[28:31], v[172:175], v[40:43]
    buffer_load_dwordx4 v[240:243], v7, s[24:27], s75 offen sc1
    v_mfma_f32_16x16x32_bf16 v[44:47], a[16:19], v[176:179], v[44:47]
    v_mfma_f32_16x16x32_bf16 v[48:51], a[20:23], v[176:179], v[48:51]
    buffer_load_dwordx4 v[244:247], v8, s[24:27], s75 offen sc1
    v_mfma_f32_16x16x32_bf16 v[52:55], a[24:27], v[176:179], v[52:55]
    v_mfma_f32_16x16x32_bf16 v[56:59], a[28:31], v[176:179], v[56:59]
    buffer_load_dwordx4 v[248:251], v9, s[24:27], s75 offen sc1
    v_mfma_f32_16x16x32_bf16 v[60:63], a[16:19], v[180:183], v[60:63]
    v_mfma_f32_16x16x32_bf16 v[64:67], a[20:23], v[180:183], v[64:67]
    s_add_u32 s75, s64, 6
    s_and_b32 s75, s75, 15
    s_lshl_b32 s75, s75, 10
    s_add_u32 s75, s75, s72
    buffer_load_dwordx4 v[156:159], v6, s[24:27], s75 offen sc1
    v_mfma_f32_16x16x32_bf16 v[68:71], a[24:27], v[180:183], v[68:71]
    v_mfma_f32_16x16x32_bf16 v[72:75], a[28:31], v[180:183], v[72:75]
    buffer_load_dwordx4 v[160:163], v7, s[24:27], s75 offen sc1
    v_mfma_f32_16x16x32_bf16 v[76:79], a[16:19], v[184:187], v[76:79]
    v_mfma_f32_16x16x32_bf16 v[80:83], a[20:23], v[184:187], v[80:83]
    buffer_load_dwordx4 v[164:167], v8, s[24:27], s75 offen sc1
    v_mfma_f32_16x16x32_bf16 v[84:87], a[24:27], v[184:187], v[84:87]
    v_mfma_f32_16x16x32_bf16 v[88:91], a[28:31], v[184:187], v[88:91]
    buffer_load_dwordx4 v[168:171], v9, s[24:27], s75 offen sc1
    s_waitcnt vmcnt(16)
    v_mfma_f32_16x16x32_bf16 v[28:31], a[32:35], v[188:191], v[28:31]
    v_mfma_f32_16x16x32_bf16 v[32:35], a[36:39], v[188:191], v[32:35]
    s_add_u32 s75, s64, 7
    s_and_b32 s75, s75, 15
    s_lshl_b32 s75, s75, 10
    s_add_u32 s75, s75, s72
    buffer_load_dwordx4 v[172:175], v6, s[24:27], s75 offen sc1
    v_mfma_f32_16x16x32_bf16 v[36:39], a[40:43], v[188:191], v[36:39]
    v_mfma_f32_16x16x32_bf16 v[40:43], a[44:47], v[188:191], v[40:43]
    v_mfma_f32_16x16x32_bf16 v[44:47], a[32:35], v[192:195], v[44:47]
    v_mfma_f32_16x16x32_bf16 v[48:51], a[36:39], v[192:195], v[48:51]
    buffer_load_dwordx4 v[176:179], v7, s[24:27], s75 offen sc1
    v_mfma_f32_16x16x32_bf16 v[52:55], a[40:43], v[192:195], v[52:55]
    v_mfma_f32_16x16x32_bf16 v[56:59], a[44:47], v[192:195], v[56:59]
    v_mfma_f32_16x16x32_bf16 v[60:63], a[32:35], v[196:199], v[60:63]
    v_mfma_f32_16x16x32_bf16 v[64:67], a[36:39], v[196:199], v[64:67]
    buffer_load_dwordx4 v[180:183], v8, s[24:27], s75 offen sc1
    v_mfma_f32_16x16x32_bf16 v[68:71], a[40:43], v[196:199], v[68:71]
    v_mfma_f32_16x16x32_bf16 v[72:75], a[44:47], v[196:199], v[72:75]
    v_mfma_f32_16x16x32_bf16 v[76:79], a[32:35], v[200:203], v[76:79]
    v_mfma_f32_16x16x32_bf16 v[80:83], a[36:39], v[200:203], v[80:83]
    buffer_load_dwordx4 v[184:187], v9, s[24:27], s75 offen sc1
    v_mfma_f32_16x16x32_bf16 v[84:87], a[40:43], v[200:203], v[84:87]
    v_mfma_f32_16x16x32_bf16 v[88:91], a[44:47], v[200:203], v[88:91]
    s_waitcnt vmcnt(16)
    v_mfma_f32_16x16x32_bf16 v[28:31], a[48:51], v[204:207], v[28:31]
    v_mfma_f32_16x16x32_bf16 v[32:35], a[52:55], v[204:207], v[32:35]
    s_add_u32 s75, s64, 8
    s_and_b32 s75, s75, 15
    s_lshl_b32 s75, s75, 10
    s_add_u32 s75, s75, s72
    buffer_load_dwordx4 v[188:191], v6, s[24:27], s75 offen sc1
    v_mfma_f32_16x16x32_bf16 v[36:39], a[56:59], v[204:207], v[36:39]
    v_mfma_f32_16x16x32_bf16 v[40:43], a[60:63], v[204:207], v[40:43]
    v_mfma_f32_16x16x32_bf16 v[44:47], a[48:51], v[208:211], v[44:47]
    v_mfma_f32_16x16x32_bf16 v[48:51], a[52:55], v[208:211], v[48:51]
    buffer_load_dwordx4 v[192:195], v7, s[24:27], s75 offen sc1
    v_mfma_f32_16x16x32_bf16 v[52:55], a[56:59], v[208:211], v[52:55]
    v_mfma_f32_16x16x32_bf16 v[56:59], a[60:63], v[208:211], v[56:59]
    v_mfma_f32_16x16x32_bf16 v[60:63], a[48:51], v[212:215], v[60:63]
    v_mfma_f32_16x16x32_bf16 v[64:67], a[52:55], v[212:215], v[64:67]
    buffer_load_dwordx4 v[196:199], v8, s[24:27], s75 offen sc1
    v_mfma_f32_16x16x32_bf16 v[68:71], a[56:59], v[212:215], v[68:71]
    v_mfma_f32_16x16x32_bf16 v[72:75], a[60:63], v[212:215], v[72:75]
    v_mfma_f32_16x16x32_bf16 v[76:79], a[48:51], v[216:219], v[76:79]
    v_mfma_f32_16x16x32_bf16 v[80:83], a[52:55], v[216:219], v[80:83]
    buffer_load_dwordx4 v[200:203], v9, s[24:27], s75 offen sc1
    v_mfma_f32_16x16x32_bf16 v[84:87], a[56:59], v[216:219], v[84:87]
    v_mfma_f32_16x16x32_bf16 v[88:91], a[60:63], v[216:219], v[88:91]
    s_waitcnt vmcnt(16)
    v_mfma_f32_16x16x32_bf16 v[28:31], a[64:67], v[220:223], v[28:31]
    v_mfma_f32_16x16x32_bf16 v[32:35], a[68:71], v[220:223], v[32:35]
    s_add_u32 s75, s64, 9
    s_and_b32 s75, s75, 15
    s_lshl_b32 s75, s75, 10
    s_add_u32 s75, s75, s72
    buffer_load_dwordx4 v[204:207], v6, s[24:27], s75 offen sc1
    v_mfma_f32_16x16x32_bf16 v[36:39], a[72:75], v[220:223], v[36:39]
    v_mfma_f32_16x16x32_bf16 v[40:43], a[76:79], v[220:223], v[40:43]
    v_mfma_f32_16x16x32_bf16 v[44:47], a[64:67], v[224:227], v[44:47]
    v_mfma_f32_16x16x32_bf16 v[48:51], a[68:71], v[224:227], v[48:51]
    buffer_load_dwordx4 v[208:211], v7, s[24:27], s75 offen sc1
    v_mfma_f32_16x16x32_bf16 v[52:55], a[72:75], v[224:227], v[52:55]
    v_mfma_f32_16x16x32_bf16 v[56:59], a[76:79], v[224:227], v[56:59]
    v_mfma_f32_16x16x32_bf16 v[60:63], a[64:67], v[228:231], v[60:63]
    v_mfma_f32_16x16x32_bf16 v[64:67], a[68:71], v[228:231], v[64:67]
    buffer_load_dwordx4 v[212:215], v8, s[24:27], s75 offen sc1
    v_mfma_f32_16x16x32_bf16 v[68:71], a[72:75], v[228:231], v[68:71]
    v_mfma_f32_16x16x32_bf16 v[72:75], a[76:79], v[228:231], v[72:75]
    v_mfma_f32_16x16x32_bf16 v[76:79], a[64:67], v[232:235], v[76:79]
    v_mfma_f32_16x16x32_bf16 v[80:83], a[68:71], v[232:235], v[80:83]
    buffer_load_dwordx4 v[216:219], v9, s[24:27], s75 offen sc1
    v_mfma_f32_16x16x32_bf16 v[84:87], a[72:75], v[232:235], v[84:87]
    v_mfma_f32_16x16x32_bf16 v[88:91], a[76:79], v[232:235], v[88:91]
    s_waitcnt vmcnt(16)
    v_mfma_f32_16x16x32_bf16 v[28:31], a[80:83], v[236:239], v[28:31]
    v_mfma_f32_16x16x32_bf16 v[32:35], a[84:87], v[236:239], v[32:35]
    s_add_u32 s75, s64, 10
    s_and_b32 s75, s75, 15
    s_lshl_b32 s75, s75, 10
    s_add_u32 s75, s75, s72
    buffer_load_dwordx4 v[220:223], v6, s[24:27], s75 offen sc1
    v_mfma_f32_16x16x32_bf16 v[36:39], a[88:91], v[236:239], v[36:39]
    v_mfma_f32_16x16x32_bf16 v[40:43], a[92:95], v[236:239], v[40:43]
    v_mfma_f32_16x16x32_bf16 v[44:47], a[80:83], v[240:243], v[44:47]
    v_mfma_f32_16x16x32_bf16 v[48:51], a[84:87], v[240:243], v[48:51]
    buffer_load_dwordx4 v[224:227], v7, s[24:27], s75 offen sc1
    v_mfma_f32_16x16x32_bf16 v[52:55], a[88:91], v[240:243], v[52:55]
    v_mfma_f32_16x16x32_bf16 v[56:59], a[92:95], v[240:243], v[56:59]
    v_mfma_f32_16x16x32_bf16 v[60:63], a[80:83], v[244:247], v[60:63]
    v_mfma_f32_16x16x32_bf16 v[64:67], a[84:87], v[244:247], v[64:67]
    buffer_load_dwordx4 v[228:231], v8, s[24:27], s75 offen sc1
    v_mfma_f32_16x16x32_bf16 v[68:71], a[88:91], v[244:247], v[68:71]
    v_mfma_f32_16x16x32_bf16 v[72:75], a[92:95], v[244:247], v[72:75]
    v_mfma_f32_16x16x32_bf16 v[76:79], a[80:83], v[248:251], v[76:79]
    v_mfma_f32_16x16x32_bf16 v[80:83], a[84:87], v[248:251], v[80:83]
    buffer_load_dwordx4 v[232:235], v9, s[24:27], s75 offen sc1
    v_mfma_f32_16x16x32_bf16 v[84:87], a[88:91], v[248:251], v[84:87]
    v_mfma_f32_16x16x32_bf16 v[88:91], a[92:95], v[248:251], v[88:91]
    s_waitcnt vmcnt(16)
    s_waitcnt lgkmcnt(0)
    v_mfma_f32_16x16x32_bf16 v[28:31], a[96:99], v[156:159], v[28:31]
    v_mfma_f32_16x16x32_bf16 v[32:35], a[100:103], v[156:159], v[32:35]
    s_add_u32 s75, s64, 11
    s_and_b32 s75, s75, 15
    s_lshl_b32 s75, s75, 10
    s_add_u32 s75, s75, s72
    buffer_load_dwordx4 v[236:239], v6, s[24:27], s75 offen sc1
    v_mfma_f32_16x16x32_bf16 v[36:39], a[104:107], v[156:159], v[36:39]
    v_mfma_f32_16x16x32_bf16 v[40:43], a[108:111], v[156:159], v[40:43]
    v_mfma_f32_16x16x32_bf16 v[44:47], a[96:99], v[160:163], v[44:47]
    v_mfma_f32_16x16x32_bf16 v[48:51], a[100:103], v[160:163], v[48:51]
    buffer_load_dwordx4 v[240:243], v7, s[24:27], s75 offen sc1
    v_mfma_f32_16x16x32_bf16 v[52:55], a[104:107], v[160:163], v[52:55]
    v_mfma_f32_16x16x32_bf16 v[56:59], a[108:111], v[160:163], v[56:59]
    v_mfma_f32_16x16x32_bf16 v[60:63], a[96:99], v[164:167], v[60:63]
    v_mfma_f32_16x16x32_bf16 v[64:67], a[100:103], v[164:167], v[64:67]
    buffer_load_dwordx4 v[244:247], v8, s[24:27], s75 offen sc1
    v_mfma_f32_16x16x32_bf16 v[68:71], a[104:107], v[164:167], v[68:71]
    v_mfma_f32_16x16x32_bf16 v[72:75], a[108:111], v[164:167], v[72:75]
    v_mfma_f32_16x16x32_bf16 v[76:79], a[96:99], v[168:171], v[76:79]
    v_mfma_f32_16x16x32_bf16 v[80:83], a[100:103], v[168:171], v[80:83]
    buffer_load_dwordx4 v[248:251], v9, s[24:27], s75 offen sc1
    v_mfma_f32_16x16x32_bf16 v[84:87], a[104:107], v[168:171], v[84:87]
    v_mfma_f32_16x16x32_bf16 v[88:91], a[108:111], v[168:171], v[88:91]
    s_waitcnt vmcnt(16)
    v_mfma_f32_16x16x32_bf16 v[28:31], a[112:115], v[172:175], v[28:31]
    v_mfma_f32_16x16x32_bf16 v[32:35], a[116:119], v[172:175], v[32:35]
    s_add_u32 s75, s64, 12
    s_and_b32 s75, s75, 15
    s_lshl_b32 s75, s75, 10
    s_add_u32 s75, s75, s72
    buffer_load_dwordx4 v[156:159], v6, s[24:27], s75 offen sc1
    v_mfma_f32_16x16x32_bf16 v[36:39], a[120:123], v[172:175], v[36:39]
    v_mfma_f32_16x16x32_bf16 v[40:43], a[124:127], v[172:175], v[40:43]
    v_mfma_f32_16x16x32_bf16 v[44:47], a[112:115], v[176:179], v[44:47]
    v_mfma_f32_16x16x32_bf16 v[48:51], a[116:119], v[176:179], v[48:51]
    buffer_load_dwordx4 v[160:163], v7, s[24:27], s75 offen sc1
    v_mfma_f32_16x16x32_bf16 v[52:55], a[120:123], v[176:179], v[52:55]
    v_mfma_f32_16x16x32_bf16 v[56:59], a[124:127], v[176:179], v[56:59]
    v_mfma_f32_16x16x32_bf16 v[60:63], a[112:115], v[180:183], v[60:63]
    v_mfma_f32_16x16x32_bf16 v[64:67], a[116:119], v[180:183], v[64:67]
    buffer_load_dwordx4 v[164:167], v8, s[24:27], s75 offen sc1
    v_mfma_f32_16x16x32_bf16 v[68:71], a[120:123], v[180:183], v[68:71]
    v_mfma_f32_16x16x32_bf16 v[72:75], a[124:127], v[180:183], v[72:75]
    v_mfma_f32_16x16x32_bf16 v[76:79], a[112:115], v[184:187], v[76:79]
    v_mfma_f32_16x16x32_bf16 v[80:83], a[116:119], v[184:187], v[80:83]
    buffer_load_dwordx4 v[168:171], v9, s[24:27], s75 offen sc1
    v_mfma_f32_16x16x32_bf16 v[84:87], a[120:123], v[184:187], v[84:87]
    v_mfma_f32_16x16x32_bf16 v[88:91], a[124:127], v[184:187], v[88:91]
    s_waitcnt vmcnt(16)
    v_mfma_f32_16x16x32_bf16 v[28:31], a[128:131], v[188:191], v[28:31]
    v_mfma_f32_16x16x32_bf16 v[32:35], a[132:135], v[188:191], v[32:35]
    s_add_u32 s75, s64, 13
    s_and_b32 s75, s75, 15
    s_lshl_b32 s75, s75, 10
    s_add_u32 s75, s75, s72
    buffer_load_dwordx4 v[172:175], v6, s[24:27], s75 offen sc1
    v_mfma_f32_16x16x32_bf16 v[36:39], a[136:139], v[188:191], v[36:39]
    v_mfma_f32_16x16x32_bf16 v[40:43], a[140:143], v[188:191], v[40:43]
    v_mfma_f32_16x16x32_bf16 v[44:47], a[128:131], v[192:195], v[44:47]
    v_mfma_f32_16x16x32_bf16 v[48:51], a[132:135], v[192:195], v[48:51]
    buffer_load_dwordx4 v[176:179], v7, s[24:27], s75 offen sc1
    v_mfma_f32_16x16x32_bf16 v[52:55], a[136:139], v[192:195], v[52:55]
    v_mfma_f32_16x16x32_bf16 v[56:59], a[140:143], v[192:195], v[56:59]
    v_mfma_f32_16x16x32_bf16 v[60:63], a[128:131], v[196:199], v[60:63]
    v_mfma_f32_16x16x32_bf16 v[64:67], a[132:135], v[196:199], v[64:67]
    buffer_load_dwordx4 v[180:183], v8, s[24:27], s75 offen sc1
    v_mfma_f32_16x16x32_bf16 v[68:71], a[136:139], v[196:199], v[68:71]
    v_mfma_f32_16x16x32_bf16 v[72:75], a[140:143], v[196:199], v[72:75]
    v_mfma_f32_16x16x32_bf16 v[76:79], a[128:131], v[200:203], v[76:79]
    v_mfma_f32_16x16x32_bf16 v[80:83], a[132:135], v[200:203], v[80:83]
    buffer_load_dwordx4 v[184:187], v9, s[24:27], s75 offen sc1
    v_mfma_f32_16x16x32_bf16 v[84:87], a[136:139], v[200:203], v[84:87]
    v_mfma_f32_16x16x32_bf16 v[88:91], a[140:143], v[200:203], v[88:91]
    s_waitcnt vmcnt(16)
    v_mfma_f32_16x16x32_bf16 v[28:31], a[144:147], v[204:207], v[28:31]
    v_mfma_f32_16x16x32_bf16 v[32:35], a[148:151], v[204:207], v[32:35]
    s_add_u32 s75, s64, 14
    s_and_b32 s75, s75, 15
    s_lshl_b32 s75, s75, 10
    s_add_u32 s75, s75, s72
    buffer_load_dwordx4 v[188:191], v6, s[24:27], s75 offen sc1
    v_mfma_f32_16x16x32_bf16 v[36:39], a[152:155], v[204:207], v[36:39]
    v_mfma_f32_16x16x32_bf16 v[40:43], a[156:159], v[204:207], v[40:43]
    v_mfma_f32_16x16x32_bf16 v[44:47], a[144:147], v[208:211], v[44:47]
    v_mfma_f32_16x16x32_bf16 v[48:51], a[148:151], v[208:211], v[48:51]
    buffer_load_dwordx4 v[192:195], v7, s[24:27], s75 offen sc1
    v_mfma_f32_16x16x32_bf16 v[52:55], a[152:155], v[208:211], v[52:55]
    v_mfma_f32_16x16x32_bf16 v[56:59], a[156:159], v[208:211], v[56:59]
    v_mfma_f32_16x16x32_bf16 v[60:63], a[144:147], v[212:215], v[60:63]
    v_mfma_f32_16x16x32_bf16 v[64:67], a[148:151], v[212:215], v[64:67]
    buffer_load_dwordx4 v[196:199], v8, s[24:27], s75 offen sc1
    v_mfma_f32_16x16x32_bf16 v[68:71], a[152:155], v[212:215], v[68:71]
    v_mfma_f32_16x16x32_bf16 v[72:75], a[156:159], v[212:215], v[72:75]
    v_mfma_f32_16x16x32_bf16 v[76:79], a[144:147], v[216:219], v[76:79]
    v_mfma_f32_16x16x32_bf16 v[80:83], a[148:151], v[216:219], v[80:83]
    buffer_load_dwordx4 v[200:203], v9, s[24:27], s75 offen sc1
    v_mfma_f32_16x16x32_bf16 v[84:87], a[152:155], v[216:219], v[84:87]
    v_mfma_f32_16x16x32_bf16 v[88:91], a[156:159], v[216:219], v[88:91]
    s_waitcnt vmcnt(16)
    v_mfma_f32_16x16x32_bf16 v[28:31], a[160:163], v[220:223], v[28:31]
    v_mfma_f32_16x16x32_bf16 v[32:35], a[164:167], v[220:223], v[32:35]
    s_add_u32 s75, s64, 15
    s_and_b32 s75, s75, 15
    s_lshl_b32 s75, s75, 10
    s_add_u32 s75, s75, s72
    buffer_load_dwordx4 v[204:207], v6, s[24:27], s75 offen sc1
    v_mfma_f32_16x16x32_bf16 v[36:39], a[168:171], v[220:223], v[36:39]
    v_mfma_f32_16x16x32_bf16 v[40:43], a[172:175], v[220:223], v[40:43]
    v_mfma_f32_16x16x32_bf16 v[44:47], a[160:163], v[224:227], v[44:47]
    v_mfma_f32_16x16x32_bf16 v[48:51], a[164:167], v[224:227], v[48:51]
    buffer_load_dwordx4 v[208:211], v7, s[24:27], s75 offen sc1
    v_mfma_f32_16x16x32_bf16 v[52:55], a[168:171], v[224:227], v[52:55]
    v_mfma_f32_16x16x32_bf16 v[56:59], a[172:175], v[224:227], v[56:59]
    v_mfma_f32_16x16x32_bf16 v[60:63], a[160:163], v[228:231], v[60:63]
    v_mfma_f32_16x16x32_bf16 v[64:67], a[164:167], v[228:231], v[64:67]
    buffer_load_dwordx4 v[212:215], v8, s[24:27], s75 offen sc1
    v_mfma_f32_16x16x32_bf16 v[68:71], a[168:171], v[228:231], v[68:71]
    v_mfma_f32_16x16x32_bf16 v[72:75], a[172:175], v[228:231], v[72:75]
    v_mfma_f32_16x16x32_bf16 v[76:79], a[160:163], v[232:235], v[76:79]
    v_mfma_f32_16x16x32_bf16 v[80:83], a[164:167], v[232:235], v[80:83]
    buffer_load_dwordx4 v[216:219], v9, s[24:27], s75 offen sc1
    v_mfma_f32_16x16x32_bf16 v[84:87], a[168:171], v[232:235], v[84:87]
    v_mfma_f32_16x16x32_bf16 v[88:91], a[172:175], v[232:235], v[88:91]
    s_waitcnt vmcnt(16)
    v_mfma_f32_16x16x32_bf16 v[28:31], a[176:179], v[236:239], v[28:31]
    v_mfma_f32_16x16x32_bf16 v[32:35], a[180:183], v[236:239], v[32:35]
    s_add_u32 s75, s64, 0
    s_and_b32 s75, s75, 15
    s_lshl_b32 s75, s75, 10
    s_add_u32 s75, s75, s73
    buffer_load_dwordx4 v[220:223], v6, s[24:27], s75 offen sc1
    v_mfma_f32_16x16x32_bf16 v[36:39], a[184:187], v[236:239], v[36:39]
    v_mfma_f32_16x16x32_bf16 v[40:43], a[188:191], v[236:239], v[40:43]
    v_mfma_f32_16x16x32_bf16 v[44:47], a[176:179], v[240:243], v[44:47]
    v_mfma_f32_16x16x32_bf16 v[48:51], a[180:183], v[240:243], v[48:51]
    buffer_load_dwordx4 v[224:227], v7, s[24:27], s75 offen sc1
    v_mfma_f32_16x16x32_bf16 v[52:55], a[184:187], v[240:243], v[52:55]
    v_mfma_f32_16x16x32_bf16 v[56:59], a[188:191], v[240:243], v[56:59]
    v_mfma_f32_16x16x32_bf16 v[60:63], a[176:179], v[244:247], v[60:63]
    v_mfma_f32_16x16x32_bf16 v[64:67], a[180:183], v[244:247], v[64:67]
    buffer_load_dwordx4 v[228:231], v8, s[24:27], s75 offen sc1
    v_mfma_f32_16x16x32_bf16 v[68:71], a[184:187], v[244:247], v[68:71]
    v_mfma_f32_16x16x32_bf16 v[72:75], a[188:191], v[244:247], v[72:75]
    v_mfma_f32_16x16x32_bf16 v[76:79], a[176:179], v[248:251], v[76:79]
    v_mfma_f32_16x16x32_bf16 v[80:83], a[180:183], v[248:251], v[80:83]
    buffer_load_dwordx4 v[232:235], v9, s[24:27], s75 offen sc1
    v_mfma_f32_16x16x32_bf16 v[84:87], a[184:187], v[248:251], v[84:87]
    v_mfma_f32_16x16x32_bf16 v[88:91], a[188:191], v[248:251], v[88:91]
    s_waitcnt vmcnt(16)
    v_mfma_f32_16x16x32_bf16 v[28:31], a[192:195], v[156:159], v[28:31]
    v_mfma_f32_16x16x32_bf16 v[32:35], a[196:199], v[156:159], v[32:35]
    s_add_u32 s75, s64, 1
    s_and_b32 s75, s75, 15
    s_lshl_b32 s75, s75, 10
    s_add_u32 s75, s75, s73
    buffer_load_dwordx4 v[236:239], v6, s[24:27], s75 offen sc1
    v_mfma_f32_16x16x32_bf16 v[36:39], a[200:203], v[156:159], v[36:39]
    v_mfma_f32_16x16x32_bf16 v[40:43], a[204:207], v[156:159], v[40:43]
    v_mfma_f32_16x16x32_bf16 v[44:47], a[192:195], v[160:163], v[44:47]
    v_mfma_f32_16x16x32_bf16 v[48:51], a[196:199], v[160:163], v[48:51]
    buffer_load_dwordx4 v[240:243], v7, s[24:27], s75 offen sc1
    v_mfma_f32_16x16x32_bf16 v[52:55], a[200:203], v[160:163], v[52:55]
    v_mfma_f32_16x16x32_bf16 v[56:59], a[204:207], v[160:163], v[56:59]
    v_mfma_f32_16x16x32_bf16 v[60:63], a[192:195], v[164:167], v[60:63]
    v_mfma_f32_16x16x32_bf16 v[64:67], a[196:199], v[164:167], v[64:67]
    buffer_load_dwordx4 v[244:247], v8, s[24:27], s75 offen sc1
    v_mfma_f32_16x16x32_bf16 v[68:71], a[200:203], v[164:167], v[68:71]
    v_mfma_f32_16x16x32_bf16 v[72:75], a[204:207], v[164:167], v[72:75]
    v_mfma_f32_16x16x32_bf16 v[76:79], a[192:195], v[168:171], v[76:79]
    v_mfma_f32_16x16x32_bf16 v[80:83], a[196:199], v[168:171], v[80:83]
    buffer_load_dwordx4 v[248:251], v9, s[24:27], s75 offen sc1
    v_mfma_f32_16x16x32_bf16 v[84:87], a[200:203], v[168:171], v[84:87]
    v_mfma_f32_16x16x32_bf16 v[88:91], a[204:207], v[168:171], v[88:91]
    s_waitcnt vmcnt(16)
    v_mfma_f32_16x16x32_bf16 v[28:31], a[208:211], v[172:175], v[28:31]
    v_mfma_f32_16x16x32_bf16 v[32:35], a[212:215], v[172:175], v[32:35]
    s_add_u32 s75, s64, 2
    s_and_b32 s75, s75, 15
    s_lshl_b32 s75, s75, 10
    s_add_u32 s75, s75, s73
    buffer_load_dwordx4 v[156:159], v6, s[24:27], s75 offen sc1
    v_mfma_f32_16x16x32_bf16 v[36:39], a[216:219], v[172:175], v[36:39]
    v_mfma_f32_16x16x32_bf16 v[40:43], a[220:223], v[172:175], v[40:43]
    v_mfma_f32_16x16x32_bf16 v[44:47], a[208:211], v[176:179], v[44:47]
    v_mfma_f32_16x16x32_bf16 v[48:51], a[212:215], v[176:179], v[48:51]
    buffer_load_dwordx4 v[160:163], v7, s[24:27], s75 offen sc1
    v_mfma_f32_16x16x32_bf16 v[52:55], a[216:219], v[176:179], v[52:55]
    v_mfma_f32_16x16x32_bf16 v[56:59], a[220:223], v[176:179], v[56:59]
    v_mfma_f32_16x16x32_bf16 v[60:63], a[208:211], v[180:183], v[60:63]
    v_mfma_f32_16x16x32_bf16 v[64:67], a[212:215], v[180:183], v[64:67]
    buffer_load_dwordx4 v[164:167], v8, s[24:27], s75 offen sc1
    v_mfma_f32_16x16x32_bf16 v[68:71], a[216:219], v[180:183], v[68:71]
    v_mfma_f32_16x16x32_bf16 v[72:75], a[220:223], v[180:183], v[72:75]
    v_mfma_f32_16x16x32_bf16 v[76:79], a[208:211], v[184:187], v[76:79]
    v_mfma_f32_16x16x32_bf16 v[80:83], a[212:215], v[184:187], v[80:83]
    buffer_load_dwordx4 v[168:171], v9, s[24:27], s75 offen sc1
    v_mfma_f32_16x16x32_bf16 v[84:87], a[216:219], v[184:187], v[84:87]
    v_mfma_f32_16x16x32_bf16 v[88:91], a[220:223], v[184:187], v[88:91]
    s_waitcnt vmcnt(16)
    v_mfma_f32_16x16x32_bf16 v[28:31], a[224:227], v[188:191], v[28:31]
    v_mfma_f32_16x16x32_bf16 v[32:35], a[228:231], v[188:191], v[32:35]
    s_add_u32 s75, s64, 3
    s_and_b32 s75, s75, 15
    s_lshl_b32 s75, s75, 10
    s_add_u32 s75, s75, s73
    buffer_load_dwordx4 v[172:175], v6, s[24:27], s75 offen sc1
    v_mfma_f32_16x16x32_bf16 v[36:39], a[232:235], v[188:191], v[36:39]
    v_mfma_f32_16x16x32_bf16 v[40:43], a[236:239], v[188:191], v[40:43]
    v_mfma_f32_16x16x32_bf16 v[44:47], a[224:227], v[192:195], v[44:47]
    v_mfma_f32_16x16x32_bf16 v[48:51], a[228:231], v[192:195], v[48:51]
    buffer_load_dwordx4 v[176:179], v7, s[24:27], s75 offen sc1
    v_mfma_f32_16x16x32_bf16 v[52:55], a[232:235], v[192:195], v[52:55]
    v_mfma_f32_16x16x32_bf16 v[56:59], a[236:239], v[192:195], v[56:59]
    v_mfma_f32_16x16x32_bf16 v[60:63], a[224:227], v[196:199], v[60:63]
    v_mfma_f32_16x16x32_bf16 v[64:67], a[228:231], v[196:199], v[64:67]
    buffer_load_dwordx4 v[180:183], v8, s[24:27], s75 offen sc1
    v_mfma_f32_16x16x32_bf16 v[68:71], a[232:235], v[196:199], v[68:71]
    v_mfma_f32_16x16x32_bf16 v[72:75], a[236:239], v[196:199], v[72:75]
    v_mfma_f32_16x16x32_bf16 v[76:79], a[224:227], v[200:203], v[76:79]
    v_mfma_f32_16x16x32_bf16 v[80:83], a[228:231], v[200:203], v[80:83]
    buffer_load_dwordx4 v[184:187], v9, s[24:27], s75 offen sc1
    v_mfma_f32_16x16x32_bf16 v[84:87], a[232:235], v[200:203], v[84:87]
    v_mfma_f32_16x16x32_bf16 v[88:91], a[236:239], v[200:203], v[88:91]
    s_waitcnt vmcnt(16)
    v_mfma_f32_16x16x32_bf16 v[28:31], a[240:243], v[204:207], v[28:31]
    v_mfma_f32_16x16x32_bf16 v[32:35], a[244:247], v[204:207], v[32:35]
    s_add_u32 s75, s64, 4
    s_and_b32 s75, s75, 15
    s_lshl_b32 s75, s75, 10
    s_add_u32 s75, s75, s73
    buffer_load_dwordx4 v[188:191], v6, s[24:27], s75 offen sc1
    v_mfma_f32_16x16x32_bf16 v[36:39], a[248:251], v[204:207], v[36:39]
    v_mfma_f32_16x16x32_bf16 v[40:43], a[252:255], v[204:207], v[40:43]
    v_mfma_f32_16x16x32_bf16 v[44:47], a[240:243], v[208:211], v[44:47]
    v_mfma_f32_16x16x32_bf16 v[48:51], a[244:247], v[208:211], v[48:51]
    buffer_load_dwordx4 v[192:195], v7, s[24:27], s75 offen sc1
    v_mfma_f32_16x16x32_bf16 v[52:55], a[248:251], v[208:211], v[52:55]
    v_mfma_f32_16x16x32_bf16 v[56:59], a[252:255], v[208:211], v[56:59]
    v_mfma_f32_16x16x32_bf16 v[60:63], a[240:243], v[212:215], v[60:63]
    v_mfma_f32_16x16x32_bf16 v[64:67], a[244:247], v[212:215], v[64:67]
    buffer_load_dwordx4 v[196:199], v8, s[24:27], s75 offen sc1
    v_mfma_f32_16x16x32_bf16 v[68:71], a[248:251], v[212:215], v[68:71]
    v_mfma_f32_16x16x32_bf16 v[72:75], a[252:255], v[212:215], v[72:75]
    v_mfma_f32_16x16x32_bf16 v[76:79], a[240:243], v[216:219], v[76:79]
    v_mfma_f32_16x16x32_bf16 v[80:83], a[244:247], v[216:219], v[80:83]
    buffer_load_dwordx4 v[200:203], v9, s[24:27], s75 offen sc1
    v_mfma_f32_16x16x32_bf16 v[84:87], a[248:251], v[216:219], v[84:87]
    v_mfma_f32_16x16x32_bf16 v[88:91], a[252:255], v[216:219], v[88:91]
    s_waitcnt vmcnt(16)
    v_mfma_f32_16x16x32_bf16 v[92:95], a[0:3], v[220:223], 0
    v_mfma_f32_16x16x32_bf16 v[96:99], a[4:7], v[220:223], 0
    s_add_u32 s75, s64, 5
    s_and_b32 s75, s75, 15
    s_lshl_b32 s75, s75, 10
    s_add_u32 s75, s75, s73
    buffer_load_dwordx4 v[204:207], v6, s[24:27], s75 offen sc1
    v_mfma_f32_16x16x32_bf16 v[100:103], a[8:11], v[220:223], 0
    v_mfma_f32_16x16x32_bf16 v[104:107], a[12:15], v[220:223], 0
    v_mfma_f32_16x16x32_bf16 v[108:111], a[0:3], v[224:227], 0
    ds_write_b128 v252, v[44:47] offset:0
    v_mfma_f32_16x16x32_bf16 v[112:115], a[4:7], v[224:227], 0
    ds_write_b128 v252, v[48:51] offset:1024
    buffer_load_dwordx4 v[208:211], v7, s[24:27], s75 offen sc1
    v_mfma_f32_16x16x32_bf16 v[116:119], a[8:11], v[224:227], 0
    ds_write_b128 v252, v[52:55] offset:2048
    v_mfma_f32_16x16x32_bf16 v[120:123], a[12:15], v[224:227], 0
    ds_write_b128 v252, v[56:59] offset:3072
    v_mfma_f32_16x16x32_bf16 v[124:127], a[0:3], v[228:231], 0
    ds_write_b128 v252, v[60:63] offset:16384
    v_mfma_f32_16x16x32_bf16 v[128:131], a[4:7], v[228:231], 0
    ds_write_b128 v252, v[64:67] offset:17408
    buffer_load_dwordx4 v[212:215], v8, s[24:27], s75 offen sc1
    v_mfma_f32_16x16x32_bf16 v[132:135], a[8:11], v[228:231], 0
    ds_write_b128 v252, v[68:71] offset:18432
    v_mfma_f32_16x16x32_bf16 v[136:139], a[12:15], v[228:231], 0
    ds_write_b128 v252, v[72:75] offset:19456
    v_mfma_f32_16x16x32_bf16 v[140:143], a[0:3], v[232:235], 0
    ds_write_b128 v252, v[76:79] offset:32768
    v_mfma_f32_16x16x32_bf16 v[144:147], a[4:7], v[232:235], 0
    ds_write_b128 v252, v[80:83] offset:33792
    buffer_load_dwordx4 v[216:219], v9, s[24:27], s75 offen sc1
    v_mfma_f32_16x16x32_bf16 v[148:151], a[8:11], v[232:235], 0
    ds_write_b128 v252, v[84:87] offset:34816
    v_mfma_f32_16x16x32_bf16 v[152:155], a[12:15], v[232:235], 0
    ds_write_b128 v252, v[88:91] offset:35840
    s_waitcnt vmcnt(16)
    v_mfma_f32_16x16x32_bf16 v[92:95], a[16:19], v[236:239], v[92:95]
    v_mfma_f32_16x16x32_bf16 v[96:99], a[20:23], v[236:239], v[96:99]
    s_add_u32 s75, s64, 6
    s_and_b32 s75, s75, 15
    s_lshl_b32 s75, s75, 10
    s_add_u32 s75, s75, s73
    buffer_load_dwordx4 v[220:223], v6, s[24:27], s75 offen sc1
    v_mfma_f32_16x16x32_bf16 v[100:103], a[24:27], v[236:239], v[100:103]
    v_mfma_f32_16x16x32_bf16 v[104:107], a[28:31], v[236:239], v[104:107]
    v_mfma_f32_16x16x32_bf16 v[108:111], a[16:19], v[240:243], v[108:111]
    v_mfma_f32_16x16x32_bf16 v[112:115], a[20:23], v[240:243], v[112:115]
    buffer_load_dwordx4 v[224:227], v7, s[24:27], s75 offen sc1
    v_mfma_f32_16x16x32_bf16 v[116:119], a[24:27], v[240:243], v[116:119]
    v_mfma_f32_16x16x32_bf16 v[120:123], a[28:31], v[240:243], v[120:123]
    v_mfma_f32_16x16x32_bf16 v[124:127], a[16:19], v[244:247], v[124:127]
    v_mfma_f32_16x16x32_bf16 v[128:131], a[20:23], v[244:247], v[128:131]
    buffer_load_dwordx4 v[228:231], v8, s[24:27], s75 offen sc1
    v_mfma_f32_16x16x32_bf16 v[132:135], a[24:27], v[244:247], v[132:135]
    v_mfma_f32_16x16x32_bf16 v[136:139], a[28:31], v[244:247], v[136:139]
    v_mfma_f32_16x16x32_bf16 v[140:143], a[16:19], v[248:251], v[140:143]
    v_mfma_f32_16x16x32_bf16 v[144:147], a[20:23], v[248:251], v[144:147]
    buffer_load_dwordx4 v[232:235], v9, s[24:27], s75 offen sc1
    v_mfma_f32_16x16x32_bf16 v[148:151], a[24:27], v[248:251], v[148:151]
    v_mfma_f32_16x16x32_bf16 v[152:155], a[28:31], v[248:251], v[152:155]
    s_waitcnt lgkmcnt(0)
    s_barrier
    ds_read_b128 v[44:47], v253 offset:0
    ds_read_b128 v[48:51], v253 offset:1024
    ds_read_b128 v[52:55], v253 offset:2048
    ds_read_b128 v[56:59], v253 offset:3072
    ds_read_b128 v[60:63], v254 offset:16384
    ds_read_b128 v[64:67], v254 offset:17408
    ds_read_b128 v[68:71], v254 offset:18432
    ds_read_b128 v[72:75], v254 offset:19456
    ds_read_b128 v[76:79], v255 offset:32768
    ds_read_b128 v[80:83], v255 offset:33792
    ds_read_b128 v[84:87], v255 offset:34816
    ds_read_b128 v[88:91], v255 offset:35840
    s_waitcnt vmcnt(16)
    v_mfma_f32_16x16x32_bf16 v[92:95], a[32:35], v[156:159], v[92:95]
    v_mfma_f32_16x16x32_bf16 v[96:99], a[36:39], v[156:159], v[96:99]
    s_add_u32 s75, s64, 7
    s_and_b32 s75, s75, 15
    s_lshl_b32 s75, s75, 10
    s_add_u32 s75, s75, s73
    buffer_load_dwordx4 v[236:239], v6, s[24:27], s75 offen sc1
    v_mfma_f32_16x16x32_bf16 v[100:103], a[40:43], v[156:159], v[100:103]
    v_mfma_f32_16x16x32_bf16 v[104:107], a[44:47], v[156:159], v[104:107]
    v_mfma_f32_16x16x32_bf16 v[108:111], a[32:35], v[160:163], v[108:111]
    s_waitcnt lgkmcnt(0)
    v_add_f32 v28, v28, v44
    v_add_f32 v29, v29, v45
    v_mfma_f32_16x16x32_bf16 v[112:115], a[36:39], v[160:163], v[112:115]
    v_add_f32 v30, v30, v46
    v_add_f32 v31, v31, v47
    buffer_load_dwordx4 v[240:243], v7, s[24:27], s75 offen sc1
    v_mfma_f32_16x16x32_bf16 v[116:119], a[40:43], v[160:163], v[116:119]
    v_add_f32 v32, v32, v48
    v_add_f32 v33, v33, v49
    v_mfma_f32_16x16x32_bf16 v[120:123], a[44:47], v[160:163], v[120:123]
    v_add_f32 v34, v34, v50
    v_add_f32 v35, v35, v51
    v_mfma_f32_16x16x32_bf16 v[124:127], a[32:35], v[164:167], v[124:127]
    v_add_f32 v36, v36, v52
    v_add_f32 v37, v37, v53
    v_mfma_f32_16x16x32_bf16 v[128:131], a[36:39], v[164:167], v[128:131]
    v_add_f32 v38, v38, v54
    v_add_f32 v39, v39, v55
    buffer_load_dwordx4 v[244:247], v8, s[24:27], s75 offen sc1
    v_mfma_f32_16x16x32_bf16 v[132:135], a[40:43], v[164:167], v[132:135]
    v_add_f32 v40, v40, v56
    v_add_f32 v41, v41, v57
    v_mfma_f32_16x16x32_bf16 v[136:139], a[44:47], v[164:167], v[136:139]
    v_add_f32 v42, v42, v58
    v_add_f32 v43, v43, v59
    v_mfma_f32_16x16x32_bf16 v[140:143], a[32:35], v[168:171], v[140:143]
    v_add_f32 v60, v60, v76
    v_add_f32 v61, v61, v77
    v_mfma_f32_16x16x32_bf16 v[144:147], a[36:39], v[168:171], v[144:147]
    v_add_f32 v62, v62, v78
    v_add_f32 v63, v63, v79
    buffer_load_dwordx4 v[248:251], v9, s[24:27], s75 offen sc1
    v_mfma_f32_16x16x32_bf16 v[148:151], a[40:43], v[168:171], v[148:151]
    v_add_f32 v64, v64, v80
    v_add_f32 v65, v65, v81
    v_mfma_f32_16x16x32_bf16 v[152:155], a[44:47], v[168:171], v[152:155]
    v_add_f32 v66, v66, v82
    v_add_f32 v67, v67, v83
    s_waitcnt vmcnt(16)
    v_mfma_f32_16x16x32_bf16 v[92:95], a[48:51], v[172:175], v[92:95]
    v_add_f32 v68, v68, v84
    v_add_f32 v69, v69, v85
    v_mfma_f32_16x16x32_bf16 v[96:99], a[52:55], v[172:175], v[96:99]
    v_add_f32 v70, v70, v86
    v_add_f32 v71, v71, v87
    s_add_u32 s75, s64, 8
    s_and_b32 s75, s75, 15
    s_lshl_b32 s75, s75, 10
    s_add_u32 s75, s75, s73
    buffer_load_dwordx4 v[156:159], v6, s[24:27], s75 offen sc1
    v_mfma_f32_16x16x32_bf16 v[100:103], a[56:59], v[172:175], v[100:103]
    v_add_f32 v72, v72, v88
    v_add_f32 v73, v73, v89
    v_mfma_f32_16x16x32_bf16 v[104:107], a[60:63], v[172:175], v[104:107]
    v_add_f32 v74, v74, v90
    v_add_f32 v75, v75, v91
    v_mfma_f32_16x16x32_bf16 v[108:111], a[48:51], v[176:179], v[108:111]
    v_add_f32 v28, v28, v60
    v_add_f32 v29, v29, v61
    v_mfma_f32_16x16x32_bf16 v[112:115], a[52:55], v[176:179], v[112:115]
    v_add_f32 v30, v30, v62
    v_add_f32 v31, v31, v63
    buffer_load_dwordx4 v[160:163], v7, s[24:27], s75 offen sc1
    v_mfma_f32_16x16x32_bf16 v[116:119], a[56:59], v[176:179], v[116:119]
    v_add_f32 v32, v32, v64
    v_add_f32 v33, v33, v65
    v_mfma_f32_16x16x32_bf16 v[120:123], a[60:63], v[176:179], v[120:123]
    v_add_f32 v34, v34, v66
    v_add_f32 v35, v35, v67
    v_mfma_f32_16x16x32_bf16 v[124:127], a[48:51], v[180:183], v[124:127]
    v_add_f32 v36, v36, v68
    v_add_f32 v37, v37, v69
    v_mfma_f32_16x16x32_bf16 v[128:131], a[52:55], v[180:183], v[128:131]
    v_add_f32 v38, v38, v70
    v_add_f32 v39, v39, v71
    buffer_load_dwordx4 v[164:167], v8, s[24:27], s75 offen sc1
    v_mfma_f32_16x16x32_bf16 v[132:135], a[56:59], v[180:183], v[132:135]
    v_add_f32 v40, v40, v72
    v_add_f32 v41, v41, v73
    v_mfma_f32_16x16x32_bf16 v[136:139], a[60:63], v[180:183], v[136:139]
    v_add_f32 v42, v42, v74
    v_add_f32 v43, v43, v75
    v_mfma_f32_16x16x32_bf16 v[140:143], a[48:51], v[184:187], v[140:143]
    v_mfma_f32_16x16x32_bf16 v[144:147], a[52:55], v[184:187], v[144:147]
    buffer_load_dwordx4 v[168:171], v9, s[24:27], s75 offen sc1
    v_mfma_f32_16x16x32_bf16 v[148:151], a[56:59], v[184:187], v[148:151]
    v_mfma_f32_16x16x32_bf16 v[152:155], a[60:63], v[184:187], v[152:155]
    buffer_store_dwordx4 v[28:31], v1, s[24:27], s58 offen offset:0 sc0 sc1
    buffer_store_dwordx4 v[32:35], v1, s[24:27], s58 offen offset:1024 sc0 sc1
    buffer_store_dwordx4 v[36:39], v1, s[24:27], s58 offen offset:2048 sc0 sc1
    buffer_store_dwordx4 v[40:43], v1, s[24:27], s58 offen offset:3072 sc0 sc1
    s_waitcnt vmcnt(20)
    v_mfma_f32_16x16x32_bf16 v[92:95], a[64:67], v[188:191], v[92:95]
    v_mfma_f32_16x16x32_bf16 v[96:99], a[68:71], v[188:191], v[96:99]
    s_add_u32 s75, s64, 9
    s_and_b32 s75, s75, 15
    s_lshl_b32 s75, s75, 10
    s_add_u32 s75, s75, s73
    buffer_load_dwordx4 v[172:175], v6, s[24:27], s75 offen sc1
    v_mfma_f32_16x16x32_bf16 v[100:103], a[72:75], v[188:191], v[100:103]
    v_mfma_f32_16x16x32_bf16 v[104:107], a[76:79], v[188:191], v[104:107]
    v_mfma_f32_16x16x32_bf16 v[108:111], a[64:67], v[192:195], v[108:111]
    v_mfma_f32_16x16x32_bf16 v[112:115], a[68:71], v[192:195], v[112:115]
    buffer_load_dwordx4 v[176:179], v7, s[24:27], s75 offen sc1
    v_mfma_f32_16x16x32_bf16 v[116:119], a[72:75], v[192:195], v[116:119]
    v_mfma_f32_16x16x32_bf16 v[120:123], a[76:79], v[192:195], v[120:123]
    v_mfma_f32_16x16x32_bf16 v[124:127], a[64:67], v[196:199], v[124:127]
    v_mfma_f32_16x16x32_bf16 v[128:131], a[68:71], v[196:199], v[128:131]
    buffer_load_dwordx4 v[180:183], v8, s[24:27], s75 offen sc1
    v_mfma_f32_16x16x32_bf16 v[132:135], a[72:75], v[196:199], v[132:135]
    v_mfma_f32_16x16x32_bf16 v[136:139], a[76:79], v[196:199], v[136:139]
    v_mfma_f32_16x16x32_bf16 v[140:143], a[64:67], v[200:203], v[140:143]
    v_mfma_f32_16x16x32_bf16 v[144:147], a[68:71], v[200:203], v[144:147]
    buffer_load_dwordx4 v[184:187], v9, s[24:27], s75 offen sc1
    v_mfma_f32_16x16x32_bf16 v[148:151], a[72:75], v[200:203], v[148:151]
    v_mfma_f32_16x16x32_bf16 v[152:155], a[76:79], v[200:203], v[152:155]
    s_waitcnt vmcnt(20)
    v_mfma_f32_16x16x32_bf16 v[92:95], a[80:83], v[204:207], v[92:95]
    v_mfma_f32_16x16x32_bf16 v[96:99], a[84:87], v[204:207], v[96:99]
    s_add_u32 s75, s64, 10
    s_and_b32 s75, s75, 15
    s_lshl_b32 s75, s75, 10
    s_add_u32 s75, s75, s73
    buffer_load_dwordx4 v[188:191], v6, s[24:27], s75 offen sc1
    v_mfma_f32_16x16x32_bf16 v[100:103], a[88:91], v[204:207], v[100:103]
    v_mfma_f32_16x16x32_bf16 v[104:107], a[92:95], v[204:207], v[104:107]
    v_mfma_f32_16x16x32_bf16 v[108:111], a[80:83], v[208:211], v[108:111]
    v_mfma_f32_16x16x32_bf16 v[112:115], a[84:87], v[208:211], v[112:115]
    buffer_load_dwordx4 v[192:195], v7, s[24:27], s75 offen sc1
    v_mfma_f32_16x16x32_bf16 v[116:119], a[88:91], v[208:211], v[116:119]
    v_mfma_f32_16x16x32_bf16 v[120:123], a[92:95], v[208:211], v[120:123]
    v_mfma_f32_16x16x32_bf16 v[124:127], a[80:83], v[212:215], v[124:127]
    v_mfma_f32_16x16x32_bf16 v[128:131], a[84:87], v[212:215], v[128:131]
    buffer_load_dwordx4 v[196:199], v8, s[24:27], s75 offen sc1
    v_mfma_f32_16x16x32_bf16 v[132:135], a[88:91], v[212:215], v[132:135]
    v_mfma_f32_16x16x32_bf16 v[136:139], a[92:95], v[212:215], v[136:139]
    v_mfma_f32_16x16x32_bf16 v[140:143], a[80:83], v[216:219], v[140:143]
    v_mfma_f32_16x16x32_bf16 v[144:147], a[84:87], v[216:219], v[144:147]
    buffer_load_dwordx4 v[200:203], v9, s[24:27], s75 offen sc1
    v_mfma_f32_16x16x32_bf16 v[148:151], a[88:91], v[216:219], v[148:151]
    v_mfma_f32_16x16x32_bf16 v[152:155], a[92:95], v[216:219], v[152:155]
    s_waitcnt vmcnt(20)
    v_mfma_f32_16x16x32_bf16 v[92:95], a[96:99], v[220:223], v[92:95]
    v_mfma_f32_16x16x32_bf16 v[96:99], a[100:103], v[220:223], v[96:99]
    s_add_u32 s75, s64, 11
    s_and_b32 s75, s75, 15
    s_lshl_b32 s75, s75, 10
    s_add_u32 s75, s75, s73
    buffer_load_dwordx4 v[204:207], v6, s[24:27], s75 offen sc1
    v_mfma_f32_16x16x32_bf16 v[100:103], a[104:107], v[220:223], v[100:103]
    v_mfma_f32_16x16x32_bf16 v[104:107], a[108:111], v[220:223], v[104:107]
    v_mfma_f32_16x16x32_bf16 v[108:111], a[96:99], v[224:227], v[108:111]
    v_mfma_f32_16x16x32_bf16 v[112:115], a[100:103], v[224:227], v[112:115]
    buffer_load_dwordx4 v[208:211], v7, s[24:27], s75 offen sc1
    v_mfma_f32_16x16x32_bf16 v[116:119], a[104:107], v[224:227], v[116:119]
    v_mfma_f32_16x16x32_bf16 v[120:123], a[108:111], v[224:227], v[120:123]
    v_mfma_f32_16x16x32_bf16 v[124:127], a[96:99], v[228:231], v[124:127]
    v_mfma_f32_16x16x32_bf16 v[128:131], a[100:103], v[228:231], v[128:131]
    buffer_load_dwordx4 v[212:215], v8, s[24:27], s75 offen sc1
    v_mfma_f32_16x16x32_bf16 v[132:135], a[104:107], v[228:231], v[132:135]
    v_mfma_f32_16x16x32_bf16 v[136:139], a[108:111], v[228:231], v[136:139]
    v_mfma_f32_16x16x32_bf16 v[140:143], a[96:99], v[232:235], v[140:143]
    v_mfma_f32_16x16x32_bf16 v[144:147], a[100:103], v[232:235], v[144:147]
    buffer_load_dwordx4 v[216:219], v9, s[24:27], s75 offen sc1
    v_mfma_f32_16x16x32_bf16 v[148:151], a[104:107], v[232:235], v[148:151]
    v_mfma_f32_16x16x32_bf16 v[152:155], a[108:111], v[232:235], v[152:155]
    s_waitcnt vmcnt(12)
    s_mov_b64 exec, 1
    buffer_store_dwordx2 v[22:23], v24, s[24:27], s59 offen sc0 sc1
    s_mov_b64 exec, -1
    v_mfma_f32_16x16x32_bf16 v[92:95], a[112:115], v[236:239], v[92:95]
    v_mfma_f32_16x16x32_bf16 v[96:99], a[116:119], v[236:239], v[96:99]
    s_add_u32 s75, s64, 12
    s_and_b32 s75, s75, 15
    s_lshl_b32 s75, s75, 10
    s_add_u32 s75, s75, s73
    buffer_load_dwordx4 v[220:223], v6, s[24:27], s75 offen sc1
    v_mfma_f32_16x16x32_bf16 v[100:103], a[120:123], v[236:239], v[100:103]
    v_mfma_f32_16x16x32_bf16 v[104:107], a[124:127], v[236:239], v[104:107]
    v_mfma_f32_16x16x32_bf16 v[108:111], a[112:115], v[240:243], v[108:111]
    v_mfma_f32_16x16x32_bf16 v[112:115], a[116:119], v[240:243], v[112:115]
    buffer_load_dwordx4 v[224:227], v7, s[24:27], s75 offen sc1
    v_mfma_f32_16x16x32_bf16 v[116:119], a[120:123], v[240:243], v[116:119]
    v_mfma_f32_16x16x32_bf16 v[120:123], a[124:127], v[240:243], v[120:123]
    v_mfma_f32_16x16x32_bf16 v[124:127], a[112:115], v[244:247], v[124:127]
    v_mfma_f32_16x16x32_bf16 v[128:131], a[116:119], v[244:247], v[128:131]
    buffer_load_dwordx4 v[228:231], v8, s[24:27], s75 offen sc1
    v_mfma_f32_16x16x32_bf16 v[132:135], a[120:123], v[244:247], v[132:135]
    v_mfma_f32_16x16x32_bf16 v[136:139], a[124:127], v[244:247], v[136:139]
    v_mfma_f32_16x16x32_bf16 v[140:143], a[112:115], v[248:251], v[140:143]
    v_mfma_f32_16x16x32_bf16 v[144:147], a[116:119], v[248:251], v[144:147]
    buffer_load_dwordx4 v[232:235], v9, s[24:27], s75 offen sc1
    v_mfma_f32_16x16x32_bf16 v[148:151], a[120:123], v[248:251], v[148:151]
    v_mfma_f32_16x16x32_bf16 v[152:155], a[124:127], v[248:251], v[152:155]
    v_mfma_f32_16x16x32_bf16 v[92:95], a[128:131], v[156:159], v[92:95]
    v_mfma_f32_16x16x32_bf16 v[96:99], a[132:135], v[156:159], v[96:99]
    s_add_u32 s75, s64, 13
    s_and_b32 s75, s75, 15
    s_lshl_b32 s75, s75, 10
    s_add_u32 s75, s75, s73
    buffer_load_dwordx4 v[236:239], v6, s[24:27], s75 offen sc1
    v_mfma_f32_16x16x32_bf16 v[100:103], a[136:139], v[156:159], v[100:103]
    v_mfma_f32_16x16x32_bf16 v[104:107], a[140:143], v[156:159], v[104:107]
    v_mfma_f32_16x16x32_bf16 v[108:111], a[128:131], v[160:163], v[108:111]
    v_mfma_f32_16x16x32_bf16 v[112:115], a[132:135], v[160:163], v[112:115]
    buffer_load_dwordx4 v[240:243], v7, s[24:27], s75 offen sc1
    v_mfma_f32_16x16x32_bf16 v[116:119], a[136:139], v[160:163], v[116:119]
    v_mfma_f32_16x16x32_bf16 v[120:123], a[140:143], v[160:163], v[120:123]
    v_mfma_f32_16x16x32_bf16 v[124:127], a[128:131], v[164:167], v[124:127]
    v_mfma_f32_16x16x32_bf16 v[128:131], a[132:135], v[164:167], v[128:131]
    buffer_load_dwordx4 v[244:247], v8, s[24:27], s75 offen sc1
    v_mfma_f32_16x16x32_bf16 v[132:135], a[136:139], v[164:167], v[132:135]
    v_mfma_f32_16x16x32_bf16 v[136:139], a[140:143], v[164:167], v[136:139]
    v_mfma_f32_16x16x32_bf16 v[140:143], a[128:131], v[168:171], v[140:143]
    v_mfma_f32_16x16x32_bf16 v[144:147], a[132:135], v[168:171], v[144:147]
    buffer_load_dwordx4 v[248:251], v9, s[24:27], s75 offen sc1
    v_mfma_f32_16x16x32_bf16 v[148:151], a[136:139], v[168:171], v[148:151]
    v_mfma_f32_16x16x32_bf16 v[152:155], a[140:143], v[168:171], v[152:155]
    s_waitcnt vmcnt(17)
    v_mfma_f32_16x16x32_bf16 v[92:95], a[144:147], v[172:175], v[92:95]
    v_mfma_f32_16x16x32_bf16 v[96:99], a[148:151], v[172:175], v[96:99]
    s_add_u32 s75, s64, 14
    s_and_b32 s75, s75, 15
    s_lshl_b32 s75, s75, 10
    s_add_u32 s75, s75, s73
    buffer_load_dwordx4 v[156:159], v6, s[24:27], s75 offen sc1
    v_mfma_f32_16x16x32_bf16 v[100:103], a[152:155], v[172:175], v[100:103]
    v_mfma_f32_16x16x32_bf16 v[104:107], a[156:159], v[172:175], v[104:107]
    v_mfma_f32_16x16x32_bf16 v[108:111], a[144:147], v[176:179], v[108:111]
    v_mfma_f32_16x16x32_bf16 v[112:115], a[148:151], v[176:179], v[112:115]
    buffer_load_dwordx4 v[160:163], v7, s[24:27], s75 offen sc1
    v_mfma_f32_16x16x32_bf16 v[116:119], a[152:155], v[176:179], v[116:119]
    v_mfma_f32_16x16x32_bf16 v[120:123], a[156:159], v[176:179], v[120:123]
    v_mfma_f32_16x16x32_bf16 v[124:127], a[144:147], v[180:183], v[124:127]
    v_mfma_f32_16x16x32_bf16 v[128:131], a[148:151], v[180:183], v[128:131]
    buffer_load_dwordx4 v[164:167], v8, s[24:27], s75 offen sc1
    v_mfma_f32_16x16x32_bf16 v[132:135], a[152:155], v[180:183], v[132:135]
    v_mfma_f32_16x16x32_bf16 v[136:139], a[156:159], v[180:183], v[136:139]
    v_mfma_f32_16x16x32_bf16 v[140:143], a[144:147], v[184:187], v[140:143]
    v_mfma_f32_16x16x32_bf16 v[144:147], a[148:151], v[184:187], v[144:147]
    buffer_load_dwordx4 v[168:171], v9, s[24:27], s75 offen sc1
    v_mfma_f32_16x16x32_bf16 v[148:151], a[152:155], v[184:187], v[148:151]
    v_mfma_f32_16x16x32_bf16 v[152:155], a[156:159], v[184:187], v[152:155]
    s_waitcnt vmcnt(17)
    v_mfma_f32_16x16x32_bf16 v[108:111], a[160:163], v[192:195], v[108:111]
    v_mfma_f32_16x16x32_bf16 v[112:115], a[164:167], v[192:195], v[112:115]
    s_add_u32 s75, s64, 15
    s_and_b32 s75, s75, 15
    s_lshl_b32 s75, s75, 10
    s_add_u32 s75, s75, s73
    buffer_load_dwordx4 v[172:175], v6, s[24:27], s75 offen sc1
    v_mfma_f32_16x16x32_bf16 v[116:119], a[168:171], v[192:195], v[116:119]
    v_mfma_f32_16x16x32_bf16 v[120:123], a[172:175], v[192:195], v[120:123]
    buffer_load_dwordx4 v[176:179], v7, s[24:27], s75 offen sc1
    v_mfma_f32_16x16x32_bf16 v[124:127], a[160:163], v[196:199], v[124:127]
    v_mfma_f32_16x16x32_bf16 v[128:131], a[164:167], v[196:199], v[128:131]
    buffer_load_dwordx4 v[180:183], v8, s[24:27], s75 offen sc1
    v_mfma_f32_16x16x32_bf16 v[132:135], a[168:171], v[196:199], v[132:135]
    v_mfma_f32_16x16x32_bf16 v[136:139], a[172:175], v[196:199], v[136:139]
    v_mfma_f32_16x16x32_bf16 v[140:143], a[160:163], v[200:203], v[140:143]
    v_mfma_f32_16x16x32_bf16 v[144:147], a[164:167], v[200:203], v[144:147]
    buffer_load_dwordx4 v[184:187], v9, s[24:27], s75 offen sc1
    v_mfma_f32_16x16x32_bf16 v[148:151], a[168:171], v[200:203], v[148:151]
    v_mfma_f32_16x16x32_bf16 v[152:155], a[172:175], v[200:203], v[152:155]
    s_waitcnt vmcnt(17)
    v_mfma_f32_16x16x32_bf16 v[108:111], a[176:179], v[208:211], v[108:111]
    v_mfma_f32_16x16x32_bf16 v[112:115], a[180:183], v[208:211], v[112:115]
    v_mfma_f32_16x16x32_bf16 v[116:119], a[184:187], v[208:211], v[116:119]
    v_mfma_f32_16x16x32_bf16 v[120:123], a[188:191], v[208:211], v[120:123]
    v_mfma_f32_16x16x32_bf16 v[124:127], a[176:179], v[212:215], v[124:127]
    v_mfma_f32_16x16x32_bf16 v[128:131], a[180:183], v[212:215], v[128:131]
    v_mfma_f32_16x16x32_bf16 v[132:135], a[184:187], v[212:215], v[132:135]
    v_mfma_f32_16x16x32_bf16 v[136:139], a[188:191], v[212:215], v[136:139]
    v_mfma_f32_16x16x32_bf16 v[140:143], a[176:179], v[216:219], v[140:143]
    v_mfma_f32_16x16x32_bf16 v[144:147], a[180:183], v[216:219], v[144:147]
    v_mfma_f32_16x16x32_bf16 v[148:151], a[184:187], v[216:219], v[148:151]
    v_mfma_f32_16x16x32_bf16 v[152:155], a[188:191], v[216:219], v[152:155]
    s_waitcnt vmcnt(12)
    buffer_load_dwordx2 v[26:27], v24, s[24:27], s69 offen sc1
    v_mfma_f32_16x16x32_bf16 v[108:111], a[192:195], v[224:227], v[108:111]
    v_mfma_f32_16x16x32_bf16 v[112:115], a[196:199], v[224:227], v[112:115]
    v_mfma_f32_16x16x32_bf16 v[116:119], a[200:203], v[224:227], v[116:119]
    v_mfma_f32_16x16x32_bf16 v[120:123], a[204:207], v[224:227], v[120:123]
    v_mfma_f32_16x16x32_bf16 v[124:127], a[192:195], v[228:231], v[124:127]
    v_mfma_f32_16x16x32_bf16 v[128:131], a[196:199], v[228:231], v[128:131]
    v_mfma_f32_16x16x32_bf16 v[132:135], a[200:203], v[228:231], v[132:135]
    v_mfma_f32_16x16x32_bf16 v[136:139], a[204:207], v[228:231], v[136:139]
    v_mfma_f32_16x16x32_bf16 v[140:143], a[192:195], v[232:235], v[140:143]
    v_mfma_f32_16x16x32_bf16 v[144:147], a[196:199], v[232:235], v[144:147]
    v_mfma_f32_16x16x32_bf16 v[148:151], a[200:203], v[232:235], v[148:151]
    v_mfma_f32_16x16x32_bf16 v[152:155], a[204:207], v[232:235], v[152:155]
    s_waitcnt vmcnt(9)
    v_mfma_f32_16x16x32_bf16 v[108:111], a[208:211], v[240:243], v[108:111]
    v_mfma_f32_16x16x32_bf16 v[112:115], a[212:215], v[240:243], v[112:115]
    v_mfma_f32_16x16x32_bf16 v[116:119], a[216:219], v[240:243], v[116:119]
    v_mfma_f32_16x16x32_bf16 v[120:123], a[220:223], v[240:243], v[120:123]
    v_mfma_f32_16x16x32_bf16 v[124:127], a[208:211], v[244:247], v[124:127]
    v_mfma_f32_16x16x32_bf16 v[128:131], a[212:215], v[244:247], v[128:131]
    v_mfma_f32_16x16x32_bf16 v[132:135], a[216:219], v[244:247], v[132:135]
    v_mfma_f32_16x16x32_bf16 v[136:139], a[220:223], v[244:247], v[136:139]
    v_mfma_f32_16x16x32_bf16 v[140:143], a[208:211], v[248:251], v[140:143]
    v_mfma_f32_16x16x32_bf16 v[144:147], a[212:215], v[248:251], v[144:147]
    v_mfma_f32_16x16x32_bf16 v[148:151], a[216:219], v[248:251], v[148:151]
    v_mfma_f32_16x16x32_bf16 v[152:155], a[220:223], v[248:251], v[152:155]
    s_waitcnt vmcnt(0)

    v_cmp_ne_u64 vcc, v[26:27], v[22:23]
    s_nop 4
    s_cbranch_vccnz P2_pspin
P2_pback:

    buffer_load_dwordx4 v[44:47], v1, s[24:27], s74 offen offset:0 sc1
    buffer_load_dwordx4 v[48:51], v1, s[24:27], s74 offen offset:1024 sc1
    buffer_load_dwordx4 v[52:55], v1, s[24:27], s74 offen offset:2048 sc1
    buffer_load_dwordx4 v[56:59], v1, s[24:27], s74 offen offset:3072 sc1
    v_mfma_f32_16x16x32_bf16 v[108:111], a[224:227], v[160:163], v[108:111]
    v_mfma_f32_16x16x32_bf16 v[112:115], a[228:231], v[160:163], v[112:115]
    v_mfma_f32_16x16x32_bf16 v[116:119], a[232:235], v[160:163], v[116:119]
    v_mfma_f32_16x16x32_bf16 v[120:123], a[236:239], v[160:163], v[120:123]
    v_mfma_f32_16x16x32_bf16 v[124:127], a[224:227], v[164:167], v[124:127]
    v_mfma_f32_16x16x32_bf16 v[128:131], a[228:231], v[164:167], v[128:131]
    v_mfma_f32_16x16x32_bf16 v[132:135], a[232:235], v[164:167], v[132:135]
    v_mfma_f32_16x16x32_bf16 v[136:139], a[236:239], v[164:167], v[136:139]
    v_mfma_f32_16x16x32_bf16 v[140:143], a[224:227], v[168:171], v[140:143]
    v_mfma_f32_16x16x32_bf16 v[144:147], a[228:231], v[168:171], v[144:147]
    v_mfma_f32_16x16x32_bf16 v[148:151], a[232:235], v[168:171], v[148:151]
    v_mfma_f32_16x16x32_bf16 v[152:155], a[236:239], v[168:171], v[152:155]
    v_mfma_f32_16x16x32_bf16 v[108:111], a[240:243], v[176:179], v[108:111]
    v_mfma_f32_16x16x32_bf16 v[112:115], a[244:247], v[176:179], v[112:115]
    v_mfma_f32_16x16x32_bf16 v[116:119], a[248:251], v[176:179], v[116:119]
    v_mfma_f32_16x16x32_bf16 v[120:123], a[252:255], v[176:179], v[120:123]
    v_mfma_f32_16x16x32_bf16 v[124:127], a[240:243], v[180:183], v[124:127]
    v_mfma_f32_16x16x32_bf16 v[128:131], a[244:247], v[180:183], v[128:131]
    v_mfma_f32_16x16x32_bf16 v[132:135], a[248:251], v[180:183], v[132:135]
    v_mfma_f32_16x16x32_bf16 v[136:139], a[252:255], v[180:183], v[136:139]
    v_mfma_f32_16x16x32_bf16 v[140:143], a[240:243], v[184:187], v[140:143]
    v_mfma_f32_16x16x32_bf16 v[144:147], a[244:247], v[184:187], v[144:147]
    v_mfma_f32_16x16x32_bf16 v[148:151], a[248:251], v[184:187], v[148:151]
    v_mfma_f32_16x16x32_bf16 v[152:155], a[252:255], v[184:187], v[152:155]
    v_mfma_f32_16x16x32_bf16 v[92:95], a[160:163], v[188:191], v[92:95]
    v_add_u32 v252, 65536, v252
    v_add_u32 v253, 65536, v253
    v_mfma_f32_16x16x32_bf16 v[96:99], a[164:167], v[188:191], v[96:99]
    v_add_u32 v254, 65536, v254
    v_add_u32 v255, 65536, v255
    v_mfma_f32_16x16x32_bf16 v[100:103], a[168:171], v[188:191], v[100:103]
    ds_write_b128 v252, v[108:111] offset:0
    v_mfma_f32_16x16x32_bf16 v[104:107], a[172:175], v[188:191], v[104:107]
    ds_write_b128 v252, v[112:115] offset:1024
    v_mfma_f32_16x16x32_bf16 v[92:95], a[176:179], v[204:207], v[92:95]
    ds_write_b128 v252, v[116:119] offset:2048
    v_mfma_f32_16x16x32_bf16 v[96:99], a[180:183], v[204:207], v[96:99]
    ds_write_b128 v252, v[120:123] offset:3072
    v_mfma_f32_16x16x32_bf16 v[100:103], a[184:187], v[204:207], v[100:103]
    ds_write_b128 v252, v[124:127] offset:16384
    v_mfma_f32_16x16x32_bf16 v[104:107], a[188:191], v[204:207], v[104:107]
    ds_write_b128 v252, v[128:131] offset:17408
    v_mfma_f32_16x16x32_bf16 v[92:95], a[192:195], v[220:223], v[92:95]
    ds_write_b128 v252, v[132:135] offset:18432
    v_mfma_f32_16x16x32_bf16 v[96:99], a[196:199], v[220:223], v[96:99]
    ds_write_b128 v252, v[136:139] offset:19456
    v_mfma_f32_16x16x32_bf16 v[100:103], a[200:203], v[220:223], v[100:103]
    ds_write_b128 v252, v[140:143] offset:32768
    v_mfma_f32_16x16x32_bf16 v[104:107], a[204:207], v[220:223], v[104:107]
    ds_write_b128 v252, v[144:147] offset:33792
    v_mfma_f32_16x16x32_bf16 v[92:95], a[208:211], v[236:239], v[92:95]
    ds_write_b128 v252, v[148:151] offset:34816
    v_mfma_f32_16x16x32_bf16 v[96:99], a[212:215], v[236:239], v[96:99]
    ds_write_b128 v252, v[152:155] offset:35840
    v_mfma_f32_16x16x32_bf16 v[100:103], a[216:219], v[236:239], v[100:103]
    v_and_b32 v24, 15, v0
    v_mul_u32_u24 v24, 2560, v24
    v_mfma_f32_16x16x32_bf16 v[104:107], a[220:223], v[236:239], v[104:107]
    v_bfe_u32 v25, v0, 4, 1
    v_lshl_add_u32 v24, v25, 5, v24
    v_mfma_f32_16x16x32_bf16 v[92:95], a[224:227], v[156:159], v[92:95]
    v_lshrrev_b32 v25, 5, v0
    v_lshl_add_u32 v24, v25, 4, v24
    v_mfma_f32_16x16x32_bf16 v[96:99], a[228:231], v[156:159], v[96:99]
    s_lshl_b32 s3, s70, 2
    s_add_u32 s3, s3, s4
    v_mfma_f32_16x16x32_bf16 v[100:103], a[232:235], v[156:159], v[100:103]
    s_mul_i32 s3, s3, 40960
    s_mul_i32 s56, s5, 1280
    v_mfma_f32_16x16x32_bf16 v[104:107], a[236:239], v[156:159], v[104:107]
    s_add_u32 s3, s3, s56
    s_add_u32 s3, s3, s61
    v_mfma_f32_16x16x32_bf16 v[92:95], a[240:243], v[172:175], v[92:95]
    v_mfma_f32_16x16x32_bf16 v[96:99], a[244:247], v[172:175], v[96:99]
    v_mfma_f32_16x16x32_bf16 v[100:103], a[248:251], v[172:175], v[100:103]
    v_mfma_f32_16x16x32_bf16 v[104:107], a[252:255], v[172:175], v[104:107]
    s_waitcnt lgkmcnt(0)
    s_barrier
    ds_read_b128 v[108:111], v253 offset:0
    ds_read_b128 v[124:127], v254 offset:16384
    ds_read_b128 v[140:143], v255 offset:32768
    ds_read_b128 v[112:115], v253 offset:1024
    ds_read_b128 v[128:131], v254 offset:17408
    ds_read_b128 v[144:147], v255 offset:33792
    ds_read_b128 v[116:119], v253 offset:2048
    ds_read_b128 v[132:135], v254 offset:18432
    ds_read_b128 v[148:151], v255 offset:34816
    ds_read_b128 v[120:123], v253 offset:3072
    ds_read_b128 v[136:139], v254 offset:19456
    ds_read_b128 v[152:155], v255 offset:35840
    s_waitcnt vmcnt(0)
    v_pk_add_f32 v[92:93], v[92:93], v[44:45]
    v_pk_add_f32 v[94:95], v[94:95], v[46:47]
    v_pk_add_f32 v[96:97], v[96:97], v[48:49]
    v_pk_add_f32 v[98:99], v[98:99], v[50:51]
    v_pk_add_f32 v[100:101], v[100:101], v[52:53]
    v_pk_add_f32 v[102:103], v[102:103], v[54:55]
    v_pk_add_f32 v[104:105], v[104:105], v[56:57]
    v_pk_add_f32 v[106:107], v[106:107], v[58:59]
    s_waitcnt lgkmcnt(9)
    v_pk_add_f32 v[92:93], v[92:93], v[108:109]
    v_pk_add_f32 v[94:95], v[94:95], v[110:111]
    v_pk_add_f32 v[124:125], v[124:125], v[140:141]
    v_pk_add_f32 v[126:127], v[126:127], v[142:143]
    v_pk_add_f32 v[92:93], v[92:93], v[124:125]
    v_pk_add_f32 v[94:95], v[94:95], v[126:127]
    v_cvt_pk_bf16_f32 v156, v92, v93
    v_cvt_pk_bf16_f32 v157, v94, v95
    s_waitcnt lgkmcnt(6)
    v_pk_add_f32 v[96:97], v[96:97], v[112:113]
    v_pk_add_f32 v[98:99], v[98:99], v[114:115]
    v_pk_add_f32 v[128:129], v[128:129], v[144:145]
    v_pk_add_f32 v[130:131], v[130:131], v[146:147]
    v_pk_add_f32 v[96:97], v[96:97], v[128:129]
    v_pk_add_f32 v[98:99], v[98:99], v[130:131]
    v_cvt_pk_bf16_f32 v158, v96, v97
    v_cvt_pk_bf16_f32 v159, v98, v99
    s_nop 1
    v_permlane16_swap_b32 v156, v158
    v_permlane16_swap_b32 v157, v159
    buffer_store_dwordx4 v[156:159], v24, s[36:39], s3 offen offset:0
    s_waitcnt lgkmcnt(3)
    v_pk_add_f32 v[100:101], v[100:101], v[116:117]
    v_pk_add_f32 v[102:103], v[102:103], v[118:119]
    v_pk_add_f32 v[132:133], v[132:133], v[148:149]
    v_pk_add_f32 v[134:135], v[134:135], v[150:151]
    v_pk_add_f32 v[100:101], v[100:101], v[132:133]
    v_pk_add_f32 v[102:103], v[102:103], v[134:135]
    v_cvt_pk_bf16_f32 v160, v100, v101
    v_cvt_pk_bf16_f32 v161, v102, v103
    s_waitcnt lgkmcnt(0)
    v_pk_add_f32 v[104:105], v[104:105], v[120:121]
    v_pk_add_f32 v[106:107], v[106:107], v[122:123]
    v_pk_add_f32 v[136:137], v[136:137], v[152:153]
    v_pk_add_f32 v[138:139], v[138:139], v[154:155]
    v_pk_add_f32 v[104:105], v[104:105], v[136:137]
    v_pk_add_f32 v[106:107], v[106:107], v[138:139]
    v_cvt_pk_bf16_f32 v162, v104, v105
    v_cvt_pk_bf16_f32 v163, v106, v107
    s_nop 1
    v_permlane16_swap_b32 v160, v162
    v_permlane16_swap_b32 v161, v163
    buffer_store_dwordx4 v[160:163], v24, s[36:39], s3 offen offset:64
P2_done:
K_end:
    s_endpgm

P2_pspin:
    s_mov_b32 s57, 0
P2_pspin2:
    s_sleep 2
    buffer_load_dwordx2 v[26:27], v24, s[24:27], s69 offen sc1
    s_add_u32 s57, s57, 1
    s_waitcnt vmcnt(0)
    v_cmp_ne_u64 vcc, v[26:27], v[22:23]
    s_cmp_gt_u32 s57, 200000
    s_cbranch_scc1 P2_pback
    s_nop 3
    s_cbranch_vccnz P2_pspin2
    s_branch P2_pback

.p2align 10
CODE_END:
.section .rodata,"a"
.p2align 6
.amdhsa_kernel concat_heads__gqa_block_cached__gqa_block_cached__near_ridge_kernel
  .amdhsa_next_free_vgpr 512
  .amdhsa_next_free_sgpr 102
  .amdhsa_accum_offset 256
  .amdhsa_group_segment_fixed_size 0
  .amdhsa_kernarg_size 104
  .amdhsa_user_sgpr_count 2
  .amdhsa_user_sgpr_kernarg_segment_ptr 1
  .amdhsa_system_sgpr_workgroup_id_x 1
.end_amdhsa_kernel
```
